```python
import torch

def _softmax(x, axis=-1):
    return torch.softmax(x, dim=axis)
def _gelu(x):
    return torch.nn.functional.gelu(x, approximate="tanh")
def _silu(x):
    return torch.nn.functional.silu(x)
def _sigmoid(x):
    return torch.sigmoid(x)
def _layernorm(x, axis=-1, eps=1e-5):
    m = x.mean(dim=axis, keepdim=True)
    v = x.var(dim=axis, keepdim=True, unbiased=False)
    return (x - m) / torch.sqrt(v + eps)
def _scatter_add(tgt, idx, src, axis=0):
    return tgt.clone().index_add_(axis, idx, src)
def _segment_sum(src, seg, n):
    out = torch.zeros((n,) + src.shape[1:], dtype=src.dtype)
    return out.index_add_(0, seg, src)
def _pad(x, pw):
    flat = tuple(v for pair in reversed(pw) for v in pair)
    return torch.nn.functional.pad(x, flat)

kernel_name = 'concat_heads__mha_block_cached__gqa_block_cached__near_ridge'

def setup_inputs():

    _w = (lambda a: (lambda t: t.to(torch.bfloat16) if t.is_floating_point() else t)(torch.as_tensor(a)))
    def _A_setup():
        B, Sq, D = 32, 32, 512
        H, Sk, Dh = 32, 32, 128
        return {
            "x": _w((lambda *s: torch.randn(*s, dtype=torch.bfloat16) * 0.8)(B, Sq, D)),
            "k_cache": _w((lambda *s: torch.randn(*s, dtype=torch.bfloat16) * 0.8)(B, H, Sk, Dh)),
            "v_cache": _w((lambda *s: torch.randn(*s, dtype=torch.bfloat16) * 0.05)(B, H, Sk, Dh)),
            "wq": _w((lambda *s: torch.randn(*s, dtype=torch.bfloat16) * 0.8)(D, H * Dh) * (D ** -0.5)),
            "wo": _w((lambda *s: torch.randn(*s, dtype=torch.bfloat16) * 0.05)(H * Dh, D) * ((H * Dh) ** -0.5)),
        }
    _A_in = _A_setup()

    def _B_setup():
        B, Sq, D = 32, 32, 512
        Hq, Hkv, Sk, Dh = 32, 32, 32, 128
        assert Hq % Hkv == 0, (Hq, Hkv)
        return {
            "x": _w((lambda *s: torch.randn(*s, dtype=torch.bfloat16) * 0.8)(B, Sq, D)),
            "k_cache": _w((lambda *s: torch.randn(*s, dtype=torch.bfloat16) * 0.8)(B, Hkv, Sk, Dh)),
            "v_cache": _w((lambda *s: torch.randn(*s, dtype=torch.bfloat16) * 0.05)(B, Hkv, Sk, Dh)),
            "wq": _w((lambda *s: torch.randn(*s, dtype=torch.bfloat16) * 0.8)(D, Hq * Dh) * (D ** -0.5)),
            "wo": _w((lambda *s: torch.randn(*s, dtype=torch.bfloat16) * 0.05)(Hq * Dh, D) * ((Hq * Dh) ** -0.5)),
        }
    _B_in = _B_setup()

    return {
        "A_x": _A_in["x"],
        "A_k_cache": _A_in["k_cache"],
        "A_v_cache": _A_in["v_cache"],
        "A_wq": _A_in["wq"],
        "A_wo": _A_in["wo"],
        "B_x": _B_in["x"],
        "B_k_cache": _B_in["k_cache"],
        "B_v_cache": _B_in["v_cache"],
        "B_wq": _B_in["wq"],
        "B_wo": _B_in["wo"],
    }

def reference(A_x, A_k_cache, A_v_cache, A_wq, A_wo, B_x, B_k_cache, B_v_cache, B_wq, B_wo):
    def _A_ref(x, k_cache, v_cache, wq, wo):
        B, Sq, D = x.shape
        H, Dh = 32, 128
        q = (lambda x, *d: x.permute(*d))((x @ wq).reshape(B, Sq, H, Dh), 0, 2, 1, 3)
        scores = torch.einsum("bhqd,bhkd->bhqk", q, k_cache) * (Dh ** -0.5)
        p = _softmax(scores, axis=-1)
        o = torch.einsum("bhqk,bhkd->bhqd", p, v_cache)
        return (lambda x, *d: x.permute(*d))(o, 0, 2, 1, 3).reshape(B, Sq, H * Dh) @ wo

    def _B_ref(x, k_cache, v_cache, wq, wo):
        B, Sq, D = x.shape
        Hq, Dh = 32, 128
        Hkv = k_cache.shape[1]
        rep = Hq // Hkv
        q = (lambda x, *d: x.permute(*d))((x @ wq).reshape(B, Sq, Hq, Dh), 0, 2, 1, 3)
        k = (lambda x, n, axis: torch.repeat_interleave(x, n, dim=axis))(k_cache, rep, axis=1)
        v = (lambda x, n, axis: torch.repeat_interleave(x, n, dim=axis))(v_cache, rep, axis=1)
        scores = torch.einsum("bhqd,bhkd->bhqk", q, k) * (Dh ** -0.5)
        p = _softmax(scores, axis=-1)
        o = torch.einsum("bhqk,bhkd->bhqd", p, v)
        return (lambda x, *d: x.permute(*d))(o, 0, 2, 1, 3).reshape(B, Sq, Hq * Dh) @ wo

    a = _A_ref(A_x, A_k_cache, A_v_cache, A_wq, A_wo)
    b = _B_ref(B_x, B_k_cache, B_v_cache, B_wq, B_wo)
    return torch.concatenate([a, b], axis=-1)
```

```asm
; @launch grid=(256,1,1) block=(768,1,1) lds=163840
.amdgcn_target "amdgcn-amd-amdhsa--gfx950"
.text
.globl concat_heads__mha_block_cached__gqa_block_cached__near_ridge_kernel
.p2align 8
.type concat_heads__mha_block_cached__gqa_block_cached__near_ridge_kernel,@function
concat_heads__mha_block_cached__gqa_block_cached__near_ridge_kernel:
  s_cmp_ge_u32 s2, 256
  s_cbranch_scc1 K_END
  s_load_dwordx8 s[8:15], s[0:1], 0
  s_load_dwordx8 s[16:23], s[0:1], 40
  s_load_dwordx2 s[24:25], s[0:1], 96
  s_load_dwordx2 s[72:73], s[0:1], 32
  s_load_dwordx2 s[74:75], s[0:1], 72
  s_load_dwordx4 s[4:7], s[0:1], 80
  s_and_b32 s26, s2, 7
  s_lshr_b32 s27, s2, 3
  s_lshr_b32 s28, s26, 2
  s_and_b32 s29, s26, 3
  v_lshrrev_b32 v1, 6, v0
  v_and_b32 v2, 63, v0
  s_nop 0
  v_readfirstlane_b32 s33, v1
  s_nop 2
  s_add_u32 s34, s33, 8
  s_sub_u32 s33, s33, 4
  s_cselect_b32 s33, s34, s33
  s_and_b32 s30, s27, 7
  s_lshr_b32 s31, s27, 3
  s_lshl_b32 s35, s31, 1
  s_add_u32 s35, s35, s30
  s_and_b32 s35, s35, 7
  v_lshlrev_b32 v3, 4, v2
  s_cmp_ge_u32 s33, 8
  s_cbranch_scc1 PRODUCER
  s_setprio 1
  s_and_b32 s32, s33, 3
  s_lshr_b32 s34, s33, 2
  v_and_b32 v20, 3, v2
  v_bfe_u32 v21, v2, 3, 1
  v_lshl_add_u32 v21, v21, 2, v20
  v_lshrrev_b32 v22, 5, v2
  v_xor_b32 v21, v21, v22
  v_lshlrev_b32 v21, 4, v21
  v_lshl_add_u32 v21, v20, 10, v21
  v_bfe_u32 v20, v2, 2, 3
  v_lshl_add_u32 v21, v20, 7, v21
  s_lshl_b32 s80, s32, 12
  v_add_u32 v21, s80, v21
  v_xor_b32 v4, 0, v21
  v_xor_b32 v5, 32, v21
  v_xor_b32 v6, 64, v21
  v_xor_b32 v7, 96, v21
  v_bfe_u32 v19, v2, 2, 2
  v_bfe_u32 v18, v2, 4, 1
  v_lshlrev_b32 v18, 2, v18
  v_and_b32 v22, 1, v2
  v_lshl_add_u32 v18, v22, 1, v18
  v_bfe_u32 v22, v2, 1, 1
  v_add_u32 v18, v18, v22
  v_lshlrev_b32 v18, 3, v18
  v_lshrrev_b32 v22, 5, v2
  v_lshl_add_u32 v22, v22, 3, v19
  v_lshl_add_u32 v18, v22, 8, v18
  s_lshl_b32 s81, s33, 13
  s_lshl_b32 s82, s34, 14
  s_add_u32 s82, s82, 16384
  v_xor_b32 v22, 0, v19
  v_lshl_add_u32 v13, v22, 6, v18
  v_add_u32 v8, s82, v13
  v_add_u32 v13, s81, v13
  v_xor_b32 v22, 1, v19
  v_lshl_add_u32 v14, v22, 6, v18
  v_add_u32 v9, s82, v14
  v_add_u32 v14, s81, v14
  v_xor_b32 v22, 2, v19
  v_lshl_add_u32 v15, v22, 6, v18
  v_add_u32 v10, s82, v15
  v_add_u32 v15, s81, v15
  v_xor_b32 v22, 3, v19
  v_lshl_add_u32 v16, v22, 6, v18
  v_add_u32 v11, s82, v16
  v_add_u32 v16, s81, v16
  v_and_b32 v20, 3, v2
  v_bfe_u32 v21, v2, 2, 1
  v_lshl_add_u32 v20, v21, 3, v20
  v_bfe_u32 v21, v2, 3, 1
  v_lshl_add_u32 v20, v21, 2, v20
  v_bfe_u32 v21, v2, 4, 1
  v_lshl_add_u32 v20, v21, 4, v20
  v_and_b32 v21, 15, v20
  v_lshrrev_b32 v22, 5, v2
  v_xor_b32 v21, v21, v22
  v_lshlrev_b32 v21, 4, v21
  v_lshl_add_u32 v12, v20, 8, v21
  s_add_u32 s81, s81, 98304
  v_add_u32 v12, s81, v12
  v_mov_b32 v32, 0
  v_mov_b32 v33, 0
  v_mov_b32 v34, 0
  v_mov_b32 v35, 0
  v_mov_b32 v36, 0
  v_mov_b32 v37, 0
  v_mov_b32 v38, 0
  v_mov_b32 v39, 0
  v_mov_b32 v40, 0
  v_mov_b32 v41, 0
  v_mov_b32 v42, 0
  v_mov_b32 v43, 0
  v_mov_b32 v44, 0
  v_mov_b32 v45, 0
  v_mov_b32 v46, 0
  v_mov_b32 v47, 0
  v_mov_b32 v48, 0
  v_mov_b32 v49, 0
  v_mov_b32 v50, 0
  v_mov_b32 v51, 0
  v_mov_b32 v52, 0
  v_mov_b32 v53, 0
  v_mov_b32 v54, 0
  v_mov_b32 v55, 0
  v_mov_b32 v56, 0
  v_mov_b32 v57, 0
  v_mov_b32 v58, 0
  v_mov_b32 v59, 0
  v_mov_b32 v60, 0
  v_mov_b32 v61, 0
  v_mov_b32 v62, 0
  v_mov_b32 v63, 0
  v_mov_b32 v64, 0
  v_mov_b32 v65, 0
  v_mov_b32 v66, 0
  v_mov_b32 v67, 0
  v_mov_b32 v68, 0
  v_mov_b32 v69, 0
  v_mov_b32 v70, 0
  v_mov_b32 v71, 0
  v_mov_b32 v72, 0
  v_mov_b32 v73, 0
  v_mov_b32 v74, 0
  v_mov_b32 v75, 0
  v_mov_b32 v76, 0
  v_mov_b32 v77, 0
  v_mov_b32 v78, 0
  v_mov_b32 v79, 0
  v_mov_b32 v80, 0
  v_mov_b32 v81, 0
  v_mov_b32 v82, 0
  v_mov_b32 v83, 0
  v_mov_b32 v84, 0
  v_mov_b32 v85, 0
  v_mov_b32 v86, 0
  v_mov_b32 v87, 0
  v_mov_b32 v88, 0
  v_mov_b32 v89, 0
  v_mov_b32 v90, 0
  v_mov_b32 v91, 0
  v_mov_b32 v92, 0
  v_mov_b32 v93, 0
  v_mov_b32 v94, 0
  v_mov_b32 v95, 0
  s_waitcnt lgkmcnt(0)
  s_add_u32 s80, s24, 0
  s_addc_u32 s81, s25, 0
  s_mov_b32 s52, s80
  s_mov_b32 s53, s81
  s_mov_b32 s54, 0x1000000
  s_mov_b32 s55, 0x00020000
  s_add_u32 s80, s24, 16777216
  s_addc_u32 s81, s25, 0
  s_mov_b32 s60, s80
  s_mov_b32 s61, s81
  s_mov_b32 s62, 0x1000000
  s_mov_b32 s63, 0x00020000
  s_add_u32 s80, s24, 33554432
  s_addc_u32 s81, s25, 0
  s_mov_b32 s64, s80
  s_mov_b32 s65, s81
  s_mov_b32 s66, 0x10000
  s_mov_b32 s67, 0x00020000
  s_mov_b32 s68, s4
  s_mov_b32 s69, s5
  s_mov_b32 s70, 0x200000
  s_mov_b32 s71, 0x00020000
  s_mov_b32 s76, s6
  s_mov_b32 s77, s7
  s_mov_b32 s78, 0x100
  s_mov_b32 s79, 0x00020000
  s_barrier
  s_mov_b32 s3, 0
  s_mov_b32 s27, 0
C1_LOOP:
  s_barrier
  ds_read_b128 v[112:115], v4
  ds_read_b64_tr_b16 v[96:97], v8 offset:0
  ds_read_b64_tr_b16 v[98:99], v8 offset:1024
  ds_read_b64_tr_b16 v[100:101], v9 offset:0
  ds_read_b64_tr_b16 v[102:103], v9 offset:1024
  ds_read_b64_tr_b16 v[104:105], v10 offset:0
  ds_read_b64_tr_b16 v[106:107], v10 offset:1024
  ds_read_b64_tr_b16 v[108:109], v11 offset:0
  ds_read_b64_tr_b16 v[110:111], v11 offset:1024
  ds_read_b128 v[116:119], v5
  ds_read_b128 v[120:123], v6
  ds_read_b128 v[124:127], v7
  s_add_u32 s27, s27, 1
  s_cmp_eq_u32 s27, 3
  s_cselect_b32 s27, 0, s27
  s_mov_b32 s80, 49152
  s_cselect_b32 s80, -98304, s80
  s_waitcnt lgkmcnt(9)
  v_mfma_f32_32x32x16_bf16 v[32:47], v[96:99], v[112:115], v[32:47]
  ds_read_b64_tr_b16 v[96:97], v8 offset:4096
  ds_read_b64_tr_b16 v[98:99], v8 offset:5120
  s_waitcnt lgkmcnt(9)
  v_mfma_f32_32x32x16_bf16 v[48:63], v[100:103], v[112:115], v[48:63]
  ds_read_b64_tr_b16 v[100:101], v9 offset:4096
  ds_read_b64_tr_b16 v[102:103], v9 offset:5120
  s_waitcnt lgkmcnt(9)
  v_mfma_f32_32x32x16_bf16 v[64:79], v[104:107], v[112:115], v[64:79]
  ds_read_b64_tr_b16 v[104:105], v10 offset:4096
  ds_read_b64_tr_b16 v[106:107], v10 offset:5120
  s_waitcnt lgkmcnt(9)
  v_mfma_f32_32x32x16_bf16 v[80:95], v[108:111], v[112:115], v[80:95]
  ds_read_b64_tr_b16 v[108:109], v11 offset:4096
  ds_read_b64_tr_b16 v[110:111], v11 offset:5120
  s_waitcnt lgkmcnt(6)
  v_mfma_f32_32x32x16_bf16 v[32:47], v[96:99], v[116:119], v[32:47]
  ds_read_b64_tr_b16 v[96:97], v8 offset:8192
  ds_read_b64_tr_b16 v[98:99], v8 offset:9216
  s_waitcnt lgkmcnt(6)
  v_mfma_f32_32x32x16_bf16 v[48:63], v[100:103], v[116:119], v[48:63]
  ds_read_b64_tr_b16 v[100:101], v9 offset:8192
  ds_read_b64_tr_b16 v[102:103], v9 offset:9216
  s_waitcnt lgkmcnt(6)
  v_mfma_f32_32x32x16_bf16 v[64:79], v[104:107], v[116:119], v[64:79]
  ds_read_b64_tr_b16 v[104:105], v10 offset:8192
  ds_read_b64_tr_b16 v[106:107], v10 offset:9216
  s_waitcnt lgkmcnt(6)
  v_mfma_f32_32x32x16_bf16 v[80:95], v[108:111], v[116:119], v[80:95]
  ds_read_b64_tr_b16 v[108:109], v11 offset:8192
  ds_read_b64_tr_b16 v[110:111], v11 offset:9216
  s_waitcnt lgkmcnt(6)
  v_mfma_f32_32x32x16_bf16 v[32:47], v[96:99], v[120:123], v[32:47]
  ds_read_b64_tr_b16 v[96:97], v8 offset:12288
  ds_read_b64_tr_b16 v[98:99], v8 offset:13312
  s_waitcnt lgkmcnt(6)
  v_mfma_f32_32x32x16_bf16 v[48:63], v[100:103], v[120:123], v[48:63]
  ds_read_b64_tr_b16 v[100:101], v9 offset:12288
  ds_read_b64_tr_b16 v[102:103], v9 offset:13312
  s_waitcnt lgkmcnt(6)
  v_mfma_f32_32x32x16_bf16 v[64:79], v[104:107], v[120:123], v[64:79]
  ds_read_b64_tr_b16 v[104:105], v10 offset:12288
  ds_read_b64_tr_b16 v[106:107], v10 offset:13312
  s_waitcnt lgkmcnt(6)
  v_mfma_f32_32x32x16_bf16 v[80:95], v[108:111], v[120:123], v[80:95]
  ds_read_b64_tr_b16 v[108:109], v11 offset:12288
  ds_read_b64_tr_b16 v[110:111], v11 offset:13312
  s_waitcnt lgkmcnt(6)
  v_mfma_f32_32x32x16_bf16 v[32:47], v[96:99], v[124:127], v[32:47]
  v_add_u32 v8, s80, v8
  v_add_u32 v4, s80, v4
  s_waitcnt lgkmcnt(4)
  v_mfma_f32_32x32x16_bf16 v[48:63], v[100:103], v[124:127], v[48:63]
  v_add_u32 v9, s80, v9
  v_add_u32 v5, s80, v5
  s_waitcnt lgkmcnt(2)
  v_mfma_f32_32x32x16_bf16 v[64:79], v[104:107], v[124:127], v[64:79]
  v_add_u32 v10, s80, v10
  v_add_u32 v6, s80, v6
  s_waitcnt lgkmcnt(0)
  v_mfma_f32_32x32x16_bf16 v[80:95], v[108:111], v[124:127], v[80:95]
  v_add_u32 v11, s80, v11
  v_add_u32 v7, s80, v7
  s_add_u32 s3, s3, 1
  s_cmp_lt_u32 s3, 8
  s_cbranch_scc1 C1_LOOP
  s_nop 7
  v_cvt_pk_bf16_f32 v96, v32, v33
  v_cvt_pk_bf16_f32 v97, v34, v35
  v_cvt_pk_bf16_f32 v98, v36, v37
  v_cvt_pk_bf16_f32 v99, v38, v39
  v_cvt_pk_bf16_f32 v100, v40, v41
  v_cvt_pk_bf16_f32 v101, v42, v43
  v_cvt_pk_bf16_f32 v102, v44, v45
  v_cvt_pk_bf16_f32 v103, v46, v47
  v_cvt_pk_bf16_f32 v104, v48, v49
  v_cvt_pk_bf16_f32 v105, v50, v51
  v_cvt_pk_bf16_f32 v106, v52, v53
  v_cvt_pk_bf16_f32 v107, v54, v55
  v_cvt_pk_bf16_f32 v108, v56, v57
  v_cvt_pk_bf16_f32 v109, v58, v59
  v_cvt_pk_bf16_f32 v110, v60, v61
  v_cvt_pk_bf16_f32 v111, v62, v63
  v_cvt_pk_bf16_f32 v112, v64, v65
  v_cvt_pk_bf16_f32 v113, v66, v67
  v_cvt_pk_bf16_f32 v114, v68, v69
  v_cvt_pk_bf16_f32 v115, v70, v71
  v_cvt_pk_bf16_f32 v116, v72, v73
  v_cvt_pk_bf16_f32 v117, v74, v75
  v_cvt_pk_bf16_f32 v118, v76, v77
  v_cvt_pk_bf16_f32 v119, v78, v79
  v_cvt_pk_bf16_f32 v120, v80, v81
  v_cvt_pk_bf16_f32 v121, v82, v83
  v_cvt_pk_bf16_f32 v122, v84, v85
  v_cvt_pk_bf16_f32 v123, v86, v87
  v_cvt_pk_bf16_f32 v124, v88, v89
  v_cvt_pk_bf16_f32 v125, v90, v91
  v_cvt_pk_bf16_f32 v126, v92, v93
  v_cvt_pk_bf16_f32 v127, v94, v95
  s_barrier
  v_mov_b32 v24, 0
  buffer_load_dwordx2 v[26:27], v24, s[76:79], 0 offen sc1
  v_xor_b32 v20, 0, v12
  ds_read_b128 v[32:35], v20
  v_xor_b32 v21, 32, v12
  ds_read_b128 v[36:39], v21
  v_xor_b32 v20, 64, v12
  ds_read_b128 v[40:43], v20
  v_xor_b32 v21, 96, v12
  ds_read_b128 v[44:47], v21
  v_xor_b32 v20, 128, v12
  ds_read_b128 v[48:51], v20
  v_xor_b32 v21, 160, v12
  ds_read_b128 v[52:55], v21
  v_xor_b32 v20, 192, v12
  ds_read_b128 v[56:59], v20
  v_xor_b32 v21, 224, v12
  ds_read_b128 v[60:63], v21
  s_waitcnt lgkmcnt(7)
  v_mfma_f32_32x32x16_bf16 v[64:79], v[32:35], v[96:99], 0
  s_waitcnt lgkmcnt(6)
  v_mfma_f32_32x32x16_bf16 v[64:79], v[36:39], v[100:103], v[64:79]
  s_waitcnt lgkmcnt(5)
  v_mfma_f32_32x32x16_bf16 v[64:79], v[40:43], v[104:107], v[64:79]
  s_waitcnt lgkmcnt(4)
  v_mfma_f32_32x32x16_bf16 v[64:79], v[44:47], v[108:111], v[64:79]
  s_waitcnt lgkmcnt(3)
  v_mfma_f32_32x32x16_bf16 v[64:79], v[48:51], v[112:115], v[64:79]
  s_waitcnt lgkmcnt(2)
  v_mfma_f32_32x32x16_bf16 v[64:79], v[52:55], v[116:119], v[64:79]
  s_waitcnt lgkmcnt(1)
  v_mfma_f32_32x32x16_bf16 v[64:79], v[56:59], v[120:123], v[64:79]
  s_waitcnt lgkmcnt(0)
  v_mfma_f32_32x32x16_bf16 v[64:79], v[60:63], v[124:127], v[64:79]
  s_mov_b32 s80, 0x3e0293ee
  s_nop 7
  s_nop 2
  v_max3_f32 v152, v64, v65, v66
  v_max3_f32 v152, v152, v67, v68
  v_max3_f32 v152, v152, v69, v70
  v_max3_f32 v152, v152, v71, v72
  v_max3_f32 v152, v152, v73, v74
  v_max3_f32 v152, v152, v75, v76
  v_max3_f32 v152, v152, v77, v78
  v_max_f32 v152, v152, v79
  v_mov_b32 v153, v152
  s_nop 1
  v_permlane32_swap_b32 v152, v153
  s_nop 1
  v_max_f32 v152, v152, v153
  v_mul_f32 v152, s80, v152
  v_fma_f32 v64, v64, s80, -v152
  v_fma_f32 v65, v65, s80, -v152
  v_fma_f32 v66, v66, s80, -v152
  v_fma_f32 v67, v67, s80, -v152
  v_fma_f32 v68, v68, s80, -v152
  v_fma_f32 v69, v69, s80, -v152
  v_fma_f32 v70, v70, s80, -v152
  v_fma_f32 v71, v71, s80, -v152
  v_fma_f32 v72, v72, s80, -v152
  v_fma_f32 v73, v73, s80, -v152
  v_fma_f32 v74, v74, s80, -v152
  v_fma_f32 v75, v75, s80, -v152
  v_fma_f32 v76, v76, s80, -v152
  v_fma_f32 v77, v77, s80, -v152
  v_fma_f32 v78, v78, s80, -v152
  v_fma_f32 v79, v79, s80, -v152
  v_exp_f32 v64, v64
  v_exp_f32 v65, v65
  v_exp_f32 v66, v66
  v_exp_f32 v67, v67
  v_exp_f32 v68, v68
  v_exp_f32 v69, v69
  v_exp_f32 v70, v70
  v_exp_f32 v71, v71
  v_exp_f32 v72, v72
  v_exp_f32 v73, v73
  v_exp_f32 v74, v74
  v_exp_f32 v75, v75
  v_exp_f32 v76, v76
  v_exp_f32 v77, v77
  v_exp_f32 v78, v78
  v_exp_f32 v79, v79
  s_nop 0
  v_add_f32 v155, v64, v65
  v_add_f32 v153, v66, v67
  v_add_f32 v155, v155, v68
  v_add_f32 v153, v153, v69
  v_add_f32 v155, v155, v70
  v_add_f32 v153, v153, v71
  v_add_f32 v155, v155, v72
  v_add_f32 v153, v153, v73
  v_add_f32 v155, v155, v74
  v_add_f32 v153, v153, v75
  v_add_f32 v155, v155, v76
  v_add_f32 v153, v153, v77
  v_add_f32 v155, v155, v78
  v_add_f32 v153, v153, v79
  v_add_f32 v155, v155, v153
  v_mov_b32 v153, v155
  s_nop 1
  v_permlane32_swap_b32 v155, v153
  s_nop 1
  v_add_f32 v155, v155, v153
  v_rcp_f32 v155, v155
  s_nop 0
  v_mul_f32 v64, v64, v155
  v_mul_f32 v65, v65, v155
  v_mul_f32 v66, v66, v155
  v_mul_f32 v67, v67, v155
  v_mul_f32 v68, v68, v155
  v_mul_f32 v69, v69, v155
  v_mul_f32 v70, v70, v155
  v_mul_f32 v71, v71, v155
  v_mul_f32 v72, v72, v155
  v_mul_f32 v73, v73, v155
  v_mul_f32 v74, v74, v155
  v_mul_f32 v75, v75, v155
  v_mul_f32 v76, v76, v155
  v_mul_f32 v77, v77, v155
  v_mul_f32 v78, v78, v155
  v_mul_f32 v79, v79, v155
  v_cvt_pk_bf16_f32 v128, v64, v65
  v_cvt_pk_bf16_f32 v129, v66, v67
  v_cvt_pk_bf16_f32 v130, v68, v69
  v_cvt_pk_bf16_f32 v131, v70, v71
  v_cvt_pk_bf16_f32 v132, v72, v73
  v_cvt_pk_bf16_f32 v133, v74, v75
  v_cvt_pk_bf16_f32 v134, v76, v77
  v_cvt_pk_bf16_f32 v135, v78, v79
  s_waitcnt vmcnt(0)
Lnonce_1:
  v_readfirstlane_b32 s84, v26
  v_readfirstlane_b32 s85, v27
  s_nop 3
  s_cmp_lg_u32 s84, 0
  s_cbranch_scc1 Lnonce_2
  buffer_load_dwordx2 v[26:27], v24, s[76:79], 0 offen sc1
  s_waitcnt vmcnt(0)
  s_branch Lnonce_1
Lnonce_2:
  s_barrier
  ds_read_b64_tr_b16 v[96:97], v13 offset:0
  ds_read_b64_tr_b16 v[98:99], v13 offset:1024
  ds_read_b64_tr_b16 v[100:101], v14 offset:0
  ds_read_b64_tr_b16 v[102:103], v14 offset:1024
  ds_read_b64_tr_b16 v[104:105], v15 offset:0
  ds_read_b64_tr_b16 v[106:107], v15 offset:1024
  ds_read_b64_tr_b16 v[108:109], v16 offset:0
  ds_read_b64_tr_b16 v[110:111], v16 offset:1024
  ds_read_b64_tr_b16 v[112:113], v13 offset:4096
  ds_read_b64_tr_b16 v[114:115], v13 offset:5120
  ds_read_b64_tr_b16 v[116:117], v14 offset:4096
  ds_read_b64_tr_b16 v[118:119], v14 offset:5120
  ds_read_b64_tr_b16 v[120:121], v15 offset:4096
  ds_read_b64_tr_b16 v[122:123], v15 offset:5120
  s_waitcnt lgkmcnt(12)
  v_mfma_f32_32x32x16_bf16 v[32:47], v[96:99], v[128:131], 0
  ds_read_b64_tr_b16 v[124:125], v16 offset:4096
  ds_read_b64_tr_b16 v[126:127], v16 offset:5120
  s_waitcnt lgkmcnt(12)
  v_mfma_f32_32x32x16_bf16 v[48:63], v[100:103], v[128:131], 0
  s_waitcnt lgkmcnt(10)
  v_mfma_f32_32x32x16_bf16 v[64:79], v[104:107], v[128:131], 0
  s_waitcnt lgkmcnt(8)
  v_mfma_f32_32x32x16_bf16 v[80:95], v[108:111], v[128:131], 0
  s_waitcnt lgkmcnt(6)
  v_mfma_f32_32x32x16_bf16 v[32:47], v[112:115], v[132:135], v[32:47]
  s_waitcnt lgkmcnt(4)
  v_mfma_f32_32x32x16_bf16 v[48:63], v[116:119], v[132:135], v[48:63]
  s_waitcnt lgkmcnt(2)
  v_mfma_f32_32x32x16_bf16 v[64:79], v[120:123], v[132:135], v[64:79]
  s_waitcnt lgkmcnt(0)
  v_mfma_f32_32x32x16_bf16 v[80:95], v[124:127], v[132:135], v[80:95]
  s_lshl_b32 s80, s26, 5
  s_lshl_b32 s81, s30, 2
  s_add_u32 s80, s80, s81
  s_add_u32 s80, s80, s32
  s_lshl_b32 s80, s80, 6
  s_lshl_b32 s81, s31, 1
  s_add_u32 s81, s81, s34
  s_lshl_b32 s81, s81, 3
  s_add_u32 s80, s80, s81
  s_lshl_b32 s80, s80, 10
  s_add_u32 s81, s80, 4096
  s_lshl_b32 s82, s34, 15
  s_lshl_b32 s83, s32, 12
  s_add_u32 s82, s82, s83
  v_add_u32 v20, s82, v3
  v_cvt_pk_bf16_f32 v136, v32, v33
  v_cvt_pk_bf16_f32 v137, v34, v35
  v_cvt_pk_bf16_f32 v138, v36, v37
  v_cvt_pk_bf16_f32 v139, v38, v39
  v_cvt_pk_bf16_f32 v140, v40, v41
  v_cvt_pk_bf16_f32 v141, v42, v43
  v_cvt_pk_bf16_f32 v142, v44, v45
  v_cvt_pk_bf16_f32 v143, v46, v47
  buffer_store_dwordx4 v[136:139], v3, s[52:55], s80 offen offset:0 sc1
  buffer_store_dwordx4 v[140:143], v3, s[52:55], s80 offen offset:1024 sc1
  v_cvt_pk_bf16_f32 v144, v48, v49
  v_cvt_pk_bf16_f32 v145, v50, v51
  v_cvt_pk_bf16_f32 v146, v52, v53
  v_cvt_pk_bf16_f32 v147, v54, v55
  v_cvt_pk_bf16_f32 v148, v56, v57
  v_cvt_pk_bf16_f32 v149, v58, v59
  v_cvt_pk_bf16_f32 v150, v60, v61
  v_cvt_pk_bf16_f32 v151, v62, v63
  buffer_store_dwordx4 v[144:147], v3, s[52:55], s80 offen offset:2048 sc1
  buffer_store_dwordx4 v[148:151], v3, s[52:55], s80 offen offset:3072 sc1
  v_cvt_pk_bf16_f32 v152, v64, v65
  v_cvt_pk_bf16_f32 v153, v66, v67
  v_cvt_pk_bf16_f32 v154, v68, v69
  v_cvt_pk_bf16_f32 v155, v70, v71
  v_cvt_pk_bf16_f32 v156, v72, v73
  v_cvt_pk_bf16_f32 v157, v74, v75
  v_cvt_pk_bf16_f32 v158, v76, v77
  v_cvt_pk_bf16_f32 v159, v78, v79
  buffer_store_dwordx4 v[152:155], v3, s[52:55], s81 offen offset:0 sc1
  buffer_store_dwordx4 v[156:159], v3, s[52:55], s81 offen offset:1024 sc1
  v_cvt_pk_bf16_f32 v160, v80, v81
  v_cvt_pk_bf16_f32 v161, v82, v83
  v_cvt_pk_bf16_f32 v162, v84, v85
  v_cvt_pk_bf16_f32 v163, v86, v87
  v_cvt_pk_bf16_f32 v164, v88, v89
  v_cvt_pk_bf16_f32 v165, v90, v91
  v_cvt_pk_bf16_f32 v166, v92, v93
  v_cvt_pk_bf16_f32 v167, v94, v95
  buffer_store_dwordx4 v[160:163], v3, s[52:55], s81 offen offset:2048 sc1
  buffer_store_dwordx4 v[164:167], v3, s[52:55], s81 offen offset:3072 sc1
  s_lshl_b32 s35, s26, 3
  s_add_u32 s35, s35, s30
  s_lshl_b32 s35, s35, 2
  s_add_u32 s35, s35, s32
  s_lshl_b32 s35, s35, 3
  s_lshl_b32 s80, s31, 1
  s_add_u32 s80, s80, s34
  s_add_u32 s35, s35, s80
  s_lshl_b32 s35, s35, 3
  s_barrier
  ds_write_b128 v20, v[136:139] offset:0
  ds_write_b128 v20, v[140:143] offset:1024
  ds_write_b128 v20, v[144:147] offset:2048
  ds_write_b128 v20, v[148:151] offset:3072
  ds_write_b128 v20, v[152:155] offset:16384
  ds_write_b128 v20, v[156:159] offset:17408
  ds_write_b128 v20, v[160:163] offset:18432
  ds_write_b128 v20, v[164:167] offset:19456
  s_and_b32 s32, s33, 1
  s_lshr_b32 s34, s33, 1
  s_and_b32 s34, s34, 1
  s_lshl_b32 s80, s34, 1
  s_add_u32 s81, s80, 0
  v_xor_b32 v22, s81, v19
  v_lshl_add_u32 v4, v22, 6, v18
  v_add_u32 v4, 65536, v4
  s_add_u32 s81, s80, 1
  v_xor_b32 v22, s81, v19
  v_lshl_add_u32 v5, v22, 6, v18
  v_add_u32 v5, 65536, v5
  s_lshl_b32 s80, s32, 13
  v_add_u32 v6, s80, v3
  v_mov_b32 v32, 0
  v_mov_b32 v33, 0
  v_mov_b32 v34, 0
  v_mov_b32 v35, 0
  v_mov_b32 v36, 0
  v_mov_b32 v37, 0
  v_mov_b32 v38, 0
  v_mov_b32 v39, 0
  v_mov_b32 v40, 0
  v_mov_b32 v41, 0
  v_mov_b32 v42, 0
  v_mov_b32 v43, 0
  v_mov_b32 v44, 0
  v_mov_b32 v45, 0
  v_mov_b32 v46, 0
  v_mov_b32 v47, 0
  v_mov_b32 v48, 0
  v_mov_b32 v49, 0
  v_mov_b32 v50, 0
  v_mov_b32 v51, 0
  v_mov_b32 v52, 0
  v_mov_b32 v53, 0
  v_mov_b32 v54, 0
  v_mov_b32 v55, 0
  v_mov_b32 v56, 0
  v_mov_b32 v57, 0
  v_mov_b32 v58, 0
  v_mov_b32 v59, 0
  v_mov_b32 v60, 0
  v_mov_b32 v61, 0
  v_mov_b32 v62, 0
  v_mov_b32 v63, 0
  v_mov_b32 v64, 0
  v_mov_b32 v65, 0
  v_mov_b32 v66, 0
  v_mov_b32 v67, 0
  v_mov_b32 v68, 0
  v_mov_b32 v69, 0
  v_mov_b32 v70, 0
  v_mov_b32 v71, 0
  v_mov_b32 v72, 0
  v_mov_b32 v73, 0
  v_mov_b32 v74, 0
  v_mov_b32 v75, 0
  v_mov_b32 v76, 0
  v_mov_b32 v77, 0
  v_mov_b32 v78, 0
  v_mov_b32 v79, 0
  v_mov_b32 v80, 0
  v_mov_b32 v81, 0
  v_mov_b32 v82, 0
  v_mov_b32 v83, 0
  v_mov_b32 v84, 0
  v_mov_b32 v85, 0
  v_mov_b32 v86, 0
  v_mov_b32 v87, 0
  v_mov_b32 v88, 0
  v_mov_b32 v89, 0
  v_mov_b32 v90, 0
  v_mov_b32 v91, 0
  v_mov_b32 v92, 0
  v_mov_b32 v93, 0
  v_mov_b32 v94, 0
  v_mov_b32 v95, 0
  s_waitcnt vmcnt(0)
  s_add_u32 s80, s35, 16384
  v_mov_b32 v26, s84
  v_mov_b32 v27, s85
  v_mov_b32 v24, 0
  s_mov_b64 exec, 1
  buffer_store_dwordx2 v[26:27], v24, s[64:67], s80 offen
  s_mov_b64 exec, -1
  v_mov_b32 v26, s84
  v_mov_b32 v27, s85
  v_mov_b32 v24, 0
  s_mov_b64 exec, 1
  buffer_store_dwordx2 v[26:27], v24, s[64:67], s35 offen sc1
  s_mov_b64 exec, -1
  s_waitcnt lgkmcnt(0)
  s_mov_b32 s3, 0
  s_barrier
  s_cmp_ge_u32 s33, 4
  s_cbranch_scc1 C_FIN
  ds_read_b128 v[128:131], v6 offset:0
  ds_read_b64_tr_b16 v[96:97], v4 offset:0
  ds_read_b64_tr_b16 v[98:99], v4 offset:1024
  ds_read_b128 v[132:135], v6 offset:4096
  ds_read_b64_tr_b16 v[100:101], v5 offset:0
  ds_read_b64_tr_b16 v[102:103], v5 offset:1024
  ds_read_b128 v[136:139], v6 offset:1024
  ds_read_b64_tr_b16 v[104:105], v4 offset:4096
  ds_read_b64_tr_b16 v[106:107], v4 offset:5120
  ds_read_b128 v[140:143], v6 offset:5120
  ds_read_b64_tr_b16 v[108:109], v5 offset:4096
  ds_read_b64_tr_b16 v[110:111], v5 offset:5120
C2_LOOP:
  s_waitcnt lgkmcnt(6)
  v_mfma_f32_32x32x16_bf16 v[32:47], v[96:99], v[128:131], v[32:47]
  ds_read_b128 v[144:147], v6 offset:2048
  v_mfma_f32_32x32x16_bf16 v[48:63], v[96:99], v[132:135], v[48:63]
  ds_read_b64_tr_b16 v[112:113], v4 offset:8192
  ds_read_b64_tr_b16 v[114:115], v4 offset:9216
  v_mfma_f32_32x32x16_bf16 v[64:79], v[100:103], v[128:131], v[64:79]
  ds_read_b128 v[148:151], v6 offset:6144
  v_mfma_f32_32x32x16_bf16 v[80:95], v[100:103], v[132:135], v[80:95]
  ds_read_b64_tr_b16 v[116:117], v5 offset:8192
  ds_read_b64_tr_b16 v[118:119], v5 offset:9216
  s_waitcnt lgkmcnt(6)
  v_mfma_f32_32x32x16_bf16 v[32:47], v[104:107], v[136:139], v[32:47]
  ds_read_b128 v[152:155], v6 offset:3072
  v_mfma_f32_32x32x16_bf16 v[48:63], v[104:107], v[140:143], v[48:63]
  ds_read_b64_tr_b16 v[120:121], v4 offset:12288
  ds_read_b64_tr_b16 v[122:123], v4 offset:13312
  v_mfma_f32_32x32x16_bf16 v[64:79], v[108:111], v[136:139], v[64:79]
  ds_read_b128 v[156:159], v6 offset:7168
  v_mfma_f32_32x32x16_bf16 v[80:95], v[108:111], v[140:143], v[80:95]
  ds_read_b64_tr_b16 v[124:125], v5 offset:12288
  ds_read_b64_tr_b16 v[126:127], v5 offset:13312
  s_waitcnt lgkmcnt(6)
  v_mfma_f32_32x32x16_bf16 v[32:47], v[112:115], v[144:147], v[32:47]
  ds_read_b128 v[128:131], v6 offset:16384
  v_mfma_f32_32x32x16_bf16 v[48:63], v[112:115], v[148:151], v[48:63]
  ds_read_b64_tr_b16 v[96:97], v4 offset:16384
  ds_read_b64_tr_b16 v[98:99], v4 offset:17408
  v_mfma_f32_32x32x16_bf16 v[64:79], v[116:119], v[144:147], v[64:79]
  ds_read_b128 v[132:135], v6 offset:20480
  v_mfma_f32_32x32x16_bf16 v[80:95], v[116:119], v[148:151], v[80:95]
  ds_read_b64_tr_b16 v[100:101], v5 offset:16384
  ds_read_b64_tr_b16 v[102:103], v5 offset:17408
  s_waitcnt lgkmcnt(6)
  v_mfma_f32_32x32x16_bf16 v[32:47], v[120:123], v[152:155], v[32:47]
  ds_read_b128 v[136:139], v6 offset:17408
  v_mfma_f32_32x32x16_bf16 v[48:63], v[120:123], v[156:159], v[48:63]
  ds_read_b64_tr_b16 v[104:105], v4 offset:20480
  ds_read_b64_tr_b16 v[106:107], v4 offset:21504
  v_mfma_f32_32x32x16_bf16 v[64:79], v[124:127], v[152:155], v[64:79]
  ds_read_b128 v[140:143], v6 offset:21504
  v_mfma_f32_32x32x16_bf16 v[80:95], v[124:127], v[156:159], v[80:95]
  ds_read_b64_tr_b16 v[108:109], v5 offset:20480
  ds_read_b64_tr_b16 v[110:111], v5 offset:21504
  s_barrier
  s_waitcnt lgkmcnt(6)
  v_mfma_f32_32x32x16_bf16 v[32:47], v[96:99], v[128:131], v[32:47]
  ds_read_b128 v[144:147], v6 offset:18432
  v_mfma_f32_32x32x16_bf16 v[48:63], v[96:99], v[132:135], v[48:63]
  ds_read_b64_tr_b16 v[112:113], v4 offset:24576
  ds_read_b64_tr_b16 v[114:115], v4 offset:25600
  v_mfma_f32_32x32x16_bf16 v[64:79], v[100:103], v[128:131], v[64:79]
  ds_read_b128 v[148:151], v6 offset:22528
  v_mfma_f32_32x32x16_bf16 v[80:95], v[100:103], v[132:135], v[80:95]
  ds_read_b64_tr_b16 v[116:117], v5 offset:24576
  ds_read_b64_tr_b16 v[118:119], v5 offset:25600
  s_waitcnt lgkmcnt(6)
  v_mfma_f32_32x32x16_bf16 v[32:47], v[104:107], v[136:139], v[32:47]
  ds_read_b128 v[152:155], v6 offset:19456
  v_mfma_f32_32x32x16_bf16 v[48:63], v[104:107], v[140:143], v[48:63]
  ds_read_b64_tr_b16 v[120:121], v4 offset:28672
  ds_read_b64_tr_b16 v[122:123], v4 offset:29696
  v_mfma_f32_32x32x16_bf16 v[64:79], v[108:111], v[136:139], v[64:79]
  ds_read_b128 v[156:159], v6 offset:23552
  v_mfma_f32_32x32x16_bf16 v[80:95], v[108:111], v[140:143], v[80:95]
  ds_read_b64_tr_b16 v[124:125], v5 offset:28672
  ds_read_b64_tr_b16 v[126:127], v5 offset:29696
  s_waitcnt lgkmcnt(6)
  v_mfma_f32_32x32x16_bf16 v[32:47], v[112:115], v[144:147], v[32:47]
  ds_read_b128 v[128:131], v6 offset:32768
  v_mfma_f32_32x32x16_bf16 v[48:63], v[112:115], v[148:151], v[48:63]
  ds_read_b64_tr_b16 v[96:97], v4 offset:32768
  ds_read_b64_tr_b16 v[98:99], v4 offset:33792
  v_mfma_f32_32x32x16_bf16 v[64:79], v[116:119], v[144:147], v[64:79]
  ds_read_b128 v[132:135], v6 offset:36864
  v_mfma_f32_32x32x16_bf16 v[80:95], v[116:119], v[148:151], v[80:95]
  ds_read_b64_tr_b16 v[100:101], v5 offset:32768
  ds_read_b64_tr_b16 v[102:103], v5 offset:33792
  s_waitcnt lgkmcnt(6)
  v_mfma_f32_32x32x16_bf16 v[32:47], v[120:123], v[152:155], v[32:47]
  ds_read_b128 v[136:139], v6 offset:33792
  v_mfma_f32_32x32x16_bf16 v[48:63], v[120:123], v[156:159], v[48:63]
  ds_read_b64_tr_b16 v[104:105], v4 offset:36864
  ds_read_b64_tr_b16 v[106:107], v4 offset:37888
  v_mfma_f32_32x32x16_bf16 v[64:79], v[124:127], v[152:155], v[64:79]
  ds_read_b128 v[140:143], v6 offset:37888
  v_mfma_f32_32x32x16_bf16 v[80:95], v[124:127], v[156:159], v[80:95]
  ds_read_b64_tr_b16 v[108:109], v5 offset:36864
  ds_read_b64_tr_b16 v[110:111], v5 offset:37888
  s_barrier
  s_waitcnt lgkmcnt(6)
  v_mfma_f32_32x32x16_bf16 v[32:47], v[96:99], v[128:131], v[32:47]
  ds_read_b128 v[144:147], v6 offset:34816
  v_mfma_f32_32x32x16_bf16 v[48:63], v[96:99], v[132:135], v[48:63]
  ds_read_b64_tr_b16 v[112:113], v4 offset:40960
  ds_read_b64_tr_b16 v[114:115], v4 offset:41984
  v_mfma_f32_32x32x16_bf16 v[64:79], v[100:103], v[128:131], v[64:79]
  ds_read_b128 v[148:151], v6 offset:38912
  v_mfma_f32_32x32x16_bf16 v[80:95], v[100:103], v[132:135], v[80:95]
  ds_read_b64_tr_b16 v[116:117], v5 offset:40960
  ds_read_b64_tr_b16 v[118:119], v5 offset:41984
  s_waitcnt lgkmcnt(6)
  v_mfma_f32_32x32x16_bf16 v[32:47], v[104:107], v[136:139], v[32:47]
  ds_read_b128 v[152:155], v6 offset:35840
  v_mfma_f32_32x32x16_bf16 v[48:63], v[104:107], v[140:143], v[48:63]
  ds_read_b64_tr_b16 v[120:121], v4 offset:45056
  ds_read_b64_tr_b16 v[122:123], v4 offset:46080
  v_mfma_f32_32x32x16_bf16 v[64:79], v[108:111], v[136:139], v[64:79]
  ds_read_b128 v[156:159], v6 offset:39936
  v_mfma_f32_32x32x16_bf16 v[80:95], v[108:111], v[140:143], v[80:95]
  ds_read_b64_tr_b16 v[124:125], v5 offset:45056
  ds_read_b64_tr_b16 v[126:127], v5 offset:46080
  s_waitcnt lgkmcnt(6)
  v_mfma_f32_32x32x16_bf16 v[32:47], v[112:115], v[144:147], v[32:47]
  ds_read_b128 v[128:131], v6 offset:49152
  v_mfma_f32_32x32x16_bf16 v[48:63], v[112:115], v[148:151], v[48:63]
  ds_read_b64_tr_b16 v[96:97], v4 offset:49152
  ds_read_b64_tr_b16 v[98:99], v4 offset:50176
  v_mfma_f32_32x32x16_bf16 v[64:79], v[116:119], v[144:147], v[64:79]
  ds_read_b128 v[132:135], v6 offset:53248
  v_mfma_f32_32x32x16_bf16 v[80:95], v[116:119], v[148:151], v[80:95]
  ds_read_b64_tr_b16 v[100:101], v5 offset:49152
  ds_read_b64_tr_b16 v[102:103], v5 offset:50176
  s_waitcnt lgkmcnt(6)
  v_mfma_f32_32x32x16_bf16 v[32:47], v[120:123], v[152:155], v[32:47]
  ds_read_b128 v[136:139], v6 offset:50176
  v_mfma_f32_32x32x16_bf16 v[48:63], v[120:123], v[156:159], v[48:63]
  ds_read_b64_tr_b16 v[104:105], v4 offset:53248
  ds_read_b64_tr_b16 v[106:107], v4 offset:54272
  v_mfma_f32_32x32x16_bf16 v[64:79], v[124:127], v[152:155], v[64:79]
  ds_read_b128 v[140:143], v6 offset:54272
  v_mfma_f32_32x32x16_bf16 v[80:95], v[124:127], v[156:159], v[80:95]
  ds_read_b64_tr_b16 v[108:109], v5 offset:53248
  ds_read_b64_tr_b16 v[110:111], v5 offset:54272
  s_barrier
  s_waitcnt lgkmcnt(6)
  v_mfma_f32_32x32x16_bf16 v[32:47], v[96:99], v[128:131], v[32:47]
  ds_read_b128 v[144:147], v6 offset:51200
  v_mfma_f32_32x32x16_bf16 v[48:63], v[96:99], v[132:135], v[48:63]
  ds_read_b64_tr_b16 v[112:113], v4 offset:57344
  ds_read_b64_tr_b16 v[114:115], v4 offset:58368
  v_mfma_f32_32x32x16_bf16 v[64:79], v[100:103], v[128:131], v[64:79]
  ds_read_b128 v[148:151], v6 offset:55296
  v_mfma_f32_32x32x16_bf16 v[80:95], v[100:103], v[132:135], v[80:95]
  ds_read_b64_tr_b16 v[116:117], v5 offset:57344
  ds_read_b64_tr_b16 v[118:119], v5 offset:58368
  s_waitcnt lgkmcnt(6)
  v_mfma_f32_32x32x16_bf16 v[32:47], v[104:107], v[136:139], v[32:47]
  ds_read_b128 v[152:155], v6 offset:52224
  v_mfma_f32_32x32x16_bf16 v[48:63], v[104:107], v[140:143], v[48:63]
  ds_read_b64_tr_b16 v[120:121], v4 offset:61440
  ds_read_b64_tr_b16 v[122:123], v4 offset:62464
  v_mfma_f32_32x32x16_bf16 v[64:79], v[108:111], v[136:139], v[64:79]
  ds_read_b128 v[156:159], v6 offset:56320
  v_mfma_f32_32x32x16_bf16 v[80:95], v[108:111], v[140:143], v[80:95]
  ds_read_b64_tr_b16 v[124:125], v5 offset:61440
  ds_read_b64_tr_b16 v[126:127], v5 offset:62464
  s_waitcnt lgkmcnt(6)
  v_mfma_f32_32x32x16_bf16 v[32:47], v[112:115], v[144:147], v[32:47]
  ds_read_b128 v[128:131], v6 offset:0
  v_mfma_f32_32x32x16_bf16 v[48:63], v[112:115], v[148:151], v[48:63]
  ds_read_b64_tr_b16 v[96:97], v4 offset:0
  ds_read_b64_tr_b16 v[98:99], v4 offset:1024
  v_mfma_f32_32x32x16_bf16 v[64:79], v[116:119], v[144:147], v[64:79]
  ds_read_b128 v[132:135], v6 offset:4096
  v_mfma_f32_32x32x16_bf16 v[80:95], v[116:119], v[148:151], v[80:95]
  ds_read_b64_tr_b16 v[100:101], v5 offset:0
  ds_read_b64_tr_b16 v[102:103], v5 offset:1024
  s_add_u32 s3, s3, 1
  s_cmp_lt_u32 s3, 4
  s_waitcnt lgkmcnt(6)
  v_mfma_f32_32x32x16_bf16 v[32:47], v[120:123], v[152:155], v[32:47]
  ds_read_b128 v[136:139], v6 offset:1024
  v_mfma_f32_32x32x16_bf16 v[48:63], v[120:123], v[156:159], v[48:63]
  ds_read_b64_tr_b16 v[104:105], v4 offset:4096
  ds_read_b64_tr_b16 v[106:107], v4 offset:5120
  v_mfma_f32_32x32x16_bf16 v[64:79], v[124:127], v[152:155], v[64:79]
  ds_read_b128 v[140:143], v6 offset:5120
  v_mfma_f32_32x32x16_bf16 v[80:95], v[124:127], v[156:159], v[80:95]
  ds_read_b64_tr_b16 v[108:109], v5 offset:4096
  ds_read_b64_tr_b16 v[110:111], v5 offset:5120
  s_cbranch_scc0 C2_DONE
  s_barrier
  s_branch C2_LOOP
C2_DONE:
  s_waitcnt lgkmcnt(0)
  s_lshl_b32 s3, s28, 3
  s_add_u32 s3, s3, s30
  s_lshl_b32 s3, s3, 2
  s_add_u32 s3, s3, s31
  s_lshl_b32 s32, s32, 1
  s_nop 7
  s_nop 3
  s_add_u32 s27, s32, 0
  s_cmp_eq_u32 s27, s29
  s_cbranch_scc1 Lsnd_3
  s_lshl_b32 s80, s3, 2
  s_add_u32 s80, s80, s27
  s_lshl_b32 s80, s80, 2
  s_add_u32 s80, s80, s29
  s_lshl_b32 s80, s80, 1
  s_add_u32 s80, s80, s34
  s_lshl_b32 s80, s80, 12
  v_cvt_pk_bf16_f32 v96, v32, v33
  v_cvt_pk_bf16_f32 v97, v34, v35
  v_cvt_pk_bf16_f32 v98, v36, v37
  v_cvt_pk_bf16_f32 v99, v38, v39
  v_cvt_pk_bf16_f32 v100, v40, v41
  v_cvt_pk_bf16_f32 v101, v42, v43
  v_cvt_pk_bf16_f32 v102, v44, v45
  v_cvt_pk_bf16_f32 v103, v46, v47
  v_cvt_pk_bf16_f32 v104, v64, v65
  v_cvt_pk_bf16_f32 v105, v66, v67
  v_cvt_pk_bf16_f32 v106, v68, v69
  v_cvt_pk_bf16_f32 v107, v70, v71
  v_cvt_pk_bf16_f32 v108, v72, v73
  v_cvt_pk_bf16_f32 v109, v74, v75
  v_cvt_pk_bf16_f32 v110, v76, v77
  v_cvt_pk_bf16_f32 v111, v78, v79
  buffer_store_dwordx4 v[96:99], v3, s[60:63], s80 offen offset:0 sc1
  buffer_store_dwordx4 v[100:103], v3, s[60:63], s80 offen offset:1024 sc1
  buffer_store_dwordx4 v[104:107], v3, s[60:63], s80 offen offset:2048 sc1
  buffer_store_dwordx4 v[108:111], v3, s[60:63], s80 offen offset:3072 sc1
Lsnd_3:
  s_add_u32 s27, s32, 1
  s_cmp_eq_u32 s27, s29
  s_cbranch_scc1 Lsnd_4
  s_lshl_b32 s80, s3, 2
  s_add_u32 s80, s80, s27
  s_lshl_b32 s80, s80, 2
  s_add_u32 s80, s80, s29
  s_lshl_b32 s80, s80, 1
  s_add_u32 s80, s80, s34
  s_lshl_b32 s80, s80, 12
  v_cvt_pk_bf16_f32 v112, v48, v49
  v_cvt_pk_bf16_f32 v113, v50, v51
  v_cvt_pk_bf16_f32 v114, v52, v53
  v_cvt_pk_bf16_f32 v115, v54, v55
  v_cvt_pk_bf16_f32 v116, v56, v57
  v_cvt_pk_bf16_f32 v117, v58, v59
  v_cvt_pk_bf16_f32 v118, v60, v61
  v_cvt_pk_bf16_f32 v119, v62, v63
  v_cvt_pk_bf16_f32 v120, v80, v81
  v_cvt_pk_bf16_f32 v121, v82, v83
  v_cvt_pk_bf16_f32 v122, v84, v85
  v_cvt_pk_bf16_f32 v123, v86, v87
  v_cvt_pk_bf16_f32 v124, v88, v89
  v_cvt_pk_bf16_f32 v125, v90, v91
  v_cvt_pk_bf16_f32 v126, v92, v93
  v_cvt_pk_bf16_f32 v127, v94, v95
  buffer_store_dwordx4 v[112:115], v3, s[60:63], s80 offen offset:0 sc1
  buffer_store_dwordx4 v[116:119], v3, s[60:63], s80 offen offset:1024 sc1
  buffer_store_dwordx4 v[120:123], v3, s[60:63], s80 offen offset:2048 sc1
  buffer_store_dwordx4 v[124:127], v3, s[60:63], s80 offen offset:3072 sc1
Lsnd_4:
  s_waitcnt vmcnt(0)
  s_add_u32 s27, s32, 0
  s_cmp_eq_u32 s27, s29
  s_cbranch_scc1 Lsf_5
  s_lshl_b32 s80, s3, 2
  s_add_u32 s80, s80, s27
  s_lshl_b32 s80, s80, 1
  s_add_u32 s80, s80, s34
  s_lshl_b32 s80, s80, 2
  s_add_u32 s80, s80, s29
  s_lshl_b32 s80, s80, 3
  s_add_u32 s80, s80, 32768
  v_mov_b32 v26, s84
  v_mov_b32 v27, s85
  v_mov_b32 v24, 0
  s_mov_b64 exec, 1
  buffer_store_dwordx2 v[26:27], v24, s[64:67], s80 offen sc1
  s_mov_b64 exec, -1
Lsf_5:
  s_add_u32 s27, s32, 1
  s_cmp_eq_u32 s27, s29
  s_cbranch_scc1 Lsf_6
  s_lshl_b32 s80, s3, 2
  s_add_u32 s80, s80, s27
  s_lshl_b32 s80, s80, 1
  s_add_u32 s80, s80, s34
  s_lshl_b32 s80, s80, 2
  s_add_u32 s80, s80, s29
  s_lshl_b32 s80, s80, 3
  s_add_u32 s80, s80, 32768
  v_mov_b32 v26, s84
  v_mov_b32 v27, s85
  v_mov_b32 v24, 0
  s_mov_b64 exec, 1
  buffer_store_dwordx2 v[26:27], v24, s[64:67], s80 offen sc1
  s_mov_b64 exec, -1
Lsf_6:
  s_lshr_b32 s80, s29, 1
  s_lshl_b32 s80, s80, 1
  s_cmp_eq_u32 s80, s32
  s_cbranch_scc0 C_FIN
  s_and_b32 s80, s29, 1
  s_cmp_eq_u32 s80, 0
  s_cbranch_scc0 Lk_7
  v_mov_b32 v128, v32
  v_mov_b32 v144, v64
  v_mov_b32 v129, v33
  v_mov_b32 v145, v65
  v_mov_b32 v130, v34
  v_mov_b32 v146, v66
  v_mov_b32 v131, v35
  v_mov_b32 v147, v67
  v_mov_b32 v132, v36
  v_mov_b32 v148, v68
  v_mov_b32 v133, v37
  v_mov_b32 v149, v69
  v_mov_b32 v134, v38
  v_mov_b32 v150, v70
  v_mov_b32 v135, v39
  v_mov_b32 v151, v71
  v_mov_b32 v136, v40
  v_mov_b32 v152, v72
  v_mov_b32 v137, v41
  v_mov_b32 v153, v73
  v_mov_b32 v138, v42
  v_mov_b32 v154, v74
  v_mov_b32 v139, v43
  v_mov_b32 v155, v75
  v_mov_b32 v140, v44
  v_mov_b32 v156, v76
  v_mov_b32 v141, v45
  v_mov_b32 v157, v77
  v_mov_b32 v142, v46
  v_mov_b32 v158, v78
  v_mov_b32 v143, v47
  v_mov_b32 v159, v79
  s_branch Lk_8
Lk_7:
  v_mov_b32 v128, v48
  v_mov_b32 v144, v80
  v_mov_b32 v129, v49
  v_mov_b32 v145, v81
  v_mov_b32 v130, v50
  v_mov_b32 v146, v82
  v_mov_b32 v131, v51
  v_mov_b32 v147, v83
  v_mov_b32 v132, v52
  v_mov_b32 v148, v84
  v_mov_b32 v133, v53
  v_mov_b32 v149, v85
  v_mov_b32 v134, v54
  v_mov_b32 v150, v86
  v_mov_b32 v135, v55
  v_mov_b32 v151, v87
  v_mov_b32 v136, v56
  v_mov_b32 v152, v88
  v_mov_b32 v137, v57
  v_mov_b32 v153, v89
  v_mov_b32 v138, v58
  v_mov_b32 v154, v90
  v_mov_b32 v139, v59
  v_mov_b32 v155, v91
  v_mov_b32 v140, v60
  v_mov_b32 v156, v92
  v_mov_b32 v141, v61
  v_mov_b32 v157, v93
  v_mov_b32 v142, v62
  v_mov_b32 v158, v94
  v_mov_b32 v143, v63
  v_mov_b32 v159, v95
Lk_8:
  s_lshl_b32 s80, s3, 2
  s_add_u32 s80, s80, s29
  s_lshl_b32 s80, s80, 1
  s_add_u32 s80, s80, s34
  s_lshl_b32 s80, s80, 5
  s_add_u32 s80, s80, 32768
  v_add_u32 v24, s29, v2
  v_and_b32 v24, 3, v24
  v_and_b32 v25, 3, v2
  v_cmp_ne_u32 s[82:83], 0, v25
  v_lshlrev_b32 v24, 3, v24
  v_mov_b32 v28, s84
  v_mov_b32 v29, s85
C3_POLL:
  buffer_load_dwordx2 v[26:27], v24, s[64:67], s80 offen sc1
  s_waitcnt vmcnt(0)
  v_cmp_ne_u64 vcc, v[26:27], v[28:29]
  s_nop 4
  s_and_b64 vcc, vcc, s[82:83]
  s_cbranch_vccnz C3_POLL
  s_add_u32 s82, s29, 1
  s_and_b32 s82, s82, 3
  s_lshl_b32 s80, s3, 2
  s_add_u32 s80, s80, s29
  s_lshl_b32 s80, s80, 2
  s_add_u32 s80, s80, s82
  s_lshl_b32 s80, s80, 1
  s_add_u32 s80, s80, s34
  s_lshl_b32 s80, s80, 12
  buffer_load_dwordx4 v[32:35], v3, s[60:63], s80 offen offset:0 sc1
  buffer_load_dwordx4 v[36:39], v3, s[60:63], s80 offen offset:1024 sc1
  buffer_load_dwordx4 v[40:43], v3, s[60:63], s80 offen offset:2048 sc1
  buffer_load_dwordx4 v[44:47], v3, s[60:63], s80 offen offset:3072 sc1
  s_add_u32 s82, s29, 2
  s_and_b32 s82, s82, 3
  s_lshl_b32 s80, s3, 2
  s_add_u32 s80, s80, s29
  s_lshl_b32 s80, s80, 2
  s_add_u32 s80, s80, s82
  s_lshl_b32 s80, s80, 1
  s_add_u32 s80, s80, s34
  s_lshl_b32 s80, s80, 12
  buffer_load_dwordx4 v[48:51], v3, s[60:63], s80 offen offset:0 sc1
  buffer_load_dwordx4 v[52:55], v3, s[60:63], s80 offen offset:1024 sc1
  buffer_load_dwordx4 v[56:59], v3, s[60:63], s80 offen offset:2048 sc1
  buffer_load_dwordx4 v[60:63], v3, s[60:63], s80 offen offset:3072 sc1
  s_add_u32 s82, s29, 3
  s_and_b32 s82, s82, 3
  s_lshl_b32 s80, s3, 2
  s_add_u32 s80, s80, s29
  s_lshl_b32 s80, s80, 2
  s_add_u32 s80, s80, s82
  s_lshl_b32 s80, s80, 1
  s_add_u32 s80, s80, s34
  s_lshl_b32 s80, s80, 12
  buffer_load_dwordx4 v[64:67], v3, s[60:63], s80 offen offset:0 sc1
  buffer_load_dwordx4 v[68:71], v3, s[60:63], s80 offen offset:1024 sc1
  buffer_load_dwordx4 v[72:75], v3, s[60:63], s80 offen offset:2048 sc1
  buffer_load_dwordx4 v[76:79], v3, s[60:63], s80 offen offset:3072 sc1
  s_waitcnt vmcnt(8)
  v_lshlrev_b32 v112, 16, v32
  v_and_b32 v113, 0xffff0000, v32
  v_add_f32 v128, v128, v112
  v_add_f32 v129, v129, v113
  v_lshlrev_b32 v112, 16, v33
  v_and_b32 v113, 0xffff0000, v33
  v_add_f32 v130, v130, v112
  v_add_f32 v131, v131, v113
  v_lshlrev_b32 v112, 16, v34
  v_and_b32 v113, 0xffff0000, v34
  v_add_f32 v132, v132, v112
  v_add_f32 v133, v133, v113
  v_lshlrev_b32 v112, 16, v35
  v_and_b32 v113, 0xffff0000, v35
  v_add_f32 v134, v134, v112
  v_add_f32 v135, v135, v113
  v_lshlrev_b32 v112, 16, v36
  v_and_b32 v113, 0xffff0000, v36
  v_add_f32 v136, v136, v112
  v_add_f32 v137, v137, v113
  v_lshlrev_b32 v112, 16, v37
  v_and_b32 v113, 0xffff0000, v37
  v_add_f32 v138, v138, v112
  v_add_f32 v139, v139, v113
  v_lshlrev_b32 v112, 16, v38
  v_and_b32 v113, 0xffff0000, v38
  v_add_f32 v140, v140, v112
  v_add_f32 v141, v141, v113
  v_lshlrev_b32 v112, 16, v39
  v_and_b32 v113, 0xffff0000, v39
  v_add_f32 v142, v142, v112
  v_add_f32 v143, v143, v113
  v_lshlrev_b32 v112, 16, v40
  v_and_b32 v113, 0xffff0000, v40
  v_add_f32 v144, v144, v112
  v_add_f32 v145, v145, v113
  v_lshlrev_b32 v112, 16, v41
  v_and_b32 v113, 0xffff0000, v41
  v_add_f32 v146, v146, v112
  v_add_f32 v147, v147, v113
  v_lshlrev_b32 v112, 16, v42
  v_and_b32 v113, 0xffff0000, v42
  v_add_f32 v148, v148, v112
  v_add_f32 v149, v149, v113
  v_lshlrev_b32 v112, 16, v43
  v_and_b32 v113, 0xffff0000, v43
  v_add_f32 v150, v150, v112
  v_add_f32 v151, v151, v113
  v_lshlrev_b32 v112, 16, v44
  v_and_b32 v113, 0xffff0000, v44
  v_add_f32 v152, v152, v112
  v_add_f32 v153, v153, v113
  v_lshlrev_b32 v112, 16, v45
  v_and_b32 v113, 0xffff0000, v45
  v_add_f32 v154, v154, v112
  v_add_f32 v155, v155, v113
  v_lshlrev_b32 v112, 16, v46
  v_and_b32 v113, 0xffff0000, v46
  v_add_f32 v156, v156, v112
  v_add_f32 v157, v157, v113
  v_lshlrev_b32 v112, 16, v47
  v_and_b32 v113, 0xffff0000, v47
  v_add_f32 v158, v158, v112
  v_add_f32 v159, v159, v113
  s_waitcnt vmcnt(4)
  v_lshlrev_b32 v112, 16, v48
  v_and_b32 v113, 0xffff0000, v48
  v_add_f32 v128, v128, v112
  v_add_f32 v129, v129, v113
  v_lshlrev_b32 v112, 16, v49
  v_and_b32 v113, 0xffff0000, v49
  v_add_f32 v130, v130, v112
  v_add_f32 v131, v131, v113
  v_lshlrev_b32 v112, 16, v50
  v_and_b32 v113, 0xffff0000, v50
  v_add_f32 v132, v132, v112
  v_add_f32 v133, v133, v113
  v_lshlrev_b32 v112, 16, v51
  v_and_b32 v113, 0xffff0000, v51
  v_add_f32 v134, v134, v112
  v_add_f32 v135, v135, v113
  v_lshlrev_b32 v112, 16, v52
  v_and_b32 v113, 0xffff0000, v52
  v_add_f32 v136, v136, v112
  v_add_f32 v137, v137, v113
  v_lshlrev_b32 v112, 16, v53
  v_and_b32 v113, 0xffff0000, v53
  v_add_f32 v138, v138, v112
  v_add_f32 v139, v139, v113
  v_lshlrev_b32 v112, 16, v54
  v_and_b32 v113, 0xffff0000, v54
  v_add_f32 v140, v140, v112
  v_add_f32 v141, v141, v113
  v_lshlrev_b32 v112, 16, v55
  v_and_b32 v113, 0xffff0000, v55
  v_add_f32 v142, v142, v112
  v_add_f32 v143, v143, v113
  v_lshlrev_b32 v112, 16, v56
  v_and_b32 v113, 0xffff0000, v56
  v_add_f32 v144, v144, v112
  v_add_f32 v145, v145, v113
  v_lshlrev_b32 v112, 16, v57
  v_and_b32 v113, 0xffff0000, v57
  v_add_f32 v146, v146, v112
  v_add_f32 v147, v147, v113
  v_lshlrev_b32 v112, 16, v58
  v_and_b32 v113, 0xffff0000, v58
  v_add_f32 v148, v148, v112
  v_add_f32 v149, v149, v113
  v_lshlrev_b32 v112, 16, v59
  v_and_b32 v113, 0xffff0000, v59
  v_add_f32 v150, v150, v112
  v_add_f32 v151, v151, v113
  v_lshlrev_b32 v112, 16, v60
  v_and_b32 v113, 0xffff0000, v60
  v_add_f32 v152, v152, v112
  v_add_f32 v153, v153, v113
  v_lshlrev_b32 v112, 16, v61
  v_and_b32 v113, 0xffff0000, v61
  v_add_f32 v154, v154, v112
  v_add_f32 v155, v155, v113
  v_lshlrev_b32 v112, 16, v62
  v_and_b32 v113, 0xffff0000, v62
  v_add_f32 v156, v156, v112
  v_add_f32 v157, v157, v113
  v_lshlrev_b32 v112, 16, v63
  v_and_b32 v113, 0xffff0000, v63
  v_add_f32 v158, v158, v112
  v_add_f32 v159, v159, v113
  s_waitcnt vmcnt(0)
  v_lshlrev_b32 v112, 16, v64
  v_and_b32 v113, 0xffff0000, v64
  v_add_f32 v128, v128, v112
  v_add_f32 v129, v129, v113
  v_lshlrev_b32 v112, 16, v65
  v_and_b32 v113, 0xffff0000, v65
  v_add_f32 v130, v130, v112
  v_add_f32 v131, v131, v113
  v_lshlrev_b32 v112, 16, v66
  v_and_b32 v113, 0xffff0000, v66
  v_add_f32 v132, v132, v112
  v_add_f32 v133, v133, v113
  v_lshlrev_b32 v112, 16, v67
  v_and_b32 v113, 0xffff0000, v67
  v_add_f32 v134, v134, v112
  v_add_f32 v135, v135, v113
  v_lshlrev_b32 v112, 16, v68
  v_and_b32 v113, 0xffff0000, v68
  v_add_f32 v136, v136, v112
  v_add_f32 v137, v137, v113
  v_lshlrev_b32 v112, 16, v69
  v_and_b32 v113, 0xffff0000, v69
  v_add_f32 v138, v138, v112
  v_add_f32 v139, v139, v113
  v_lshlrev_b32 v112, 16, v70
  v_and_b32 v113, 0xffff0000, v70
  v_add_f32 v140, v140, v112
  v_add_f32 v141, v141, v113
  v_lshlrev_b32 v112, 16, v71
  v_and_b32 v113, 0xffff0000, v71
  v_add_f32 v142, v142, v112
  v_add_f32 v143, v143, v113
  v_lshlrev_b32 v112, 16, v72
  v_and_b32 v113, 0xffff0000, v72
  v_add_f32 v144, v144, v112
  v_add_f32 v145, v145, v113
  v_lshlrev_b32 v112, 16, v73
  v_and_b32 v113, 0xffff0000, v73
  v_add_f32 v146, v146, v112
  v_add_f32 v147, v147, v113
  v_lshlrev_b32 v112, 16, v74
  v_and_b32 v113, 0xffff0000, v74
  v_add_f32 v148, v148, v112
  v_add_f32 v149, v149, v113
  v_lshlrev_b32 v112, 16, v75
  v_and_b32 v113, 0xffff0000, v75
  v_add_f32 v150, v150, v112
  v_add_f32 v151, v151, v113
  v_lshlrev_b32 v112, 16, v76
  v_and_b32 v113, 0xffff0000, v76
  v_add_f32 v152, v152, v112
  v_add_f32 v153, v153, v113
  v_lshlrev_b32 v112, 16, v77
  v_and_b32 v113, 0xffff0000, v77
  v_add_f32 v154, v154, v112
  v_add_f32 v155, v155, v113
  v_lshlrev_b32 v112, 16, v78
  v_and_b32 v113, 0xffff0000, v78
  v_add_f32 v156, v156, v112
  v_add_f32 v157, v157, v113
  v_lshlrev_b32 v112, 16, v79
  v_and_b32 v113, 0xffff0000, v79
  v_add_f32 v158, v158, v112
  v_add_f32 v159, v159, v113
  v_cvt_pk_bf16_f32 v64, v128, v129
  v_cvt_pk_bf16_f32 v65, v130, v131
  v_cvt_pk_bf16_f32 v66, v132, v133
  v_cvt_pk_bf16_f32 v67, v134, v135
  v_cvt_pk_bf16_f32 v68, v136, v137
  v_cvt_pk_bf16_f32 v69, v138, v139
  v_cvt_pk_bf16_f32 v70, v140, v141
  v_cvt_pk_bf16_f32 v71, v142, v143
  v_cvt_pk_bf16_f32 v72, v144, v145
  v_cvt_pk_bf16_f32 v73, v146, v147
  v_cvt_pk_bf16_f32 v74, v148, v149
  v_cvt_pk_bf16_f32 v75, v150, v151
  v_cvt_pk_bf16_f32 v76, v152, v153
  v_cvt_pk_bf16_f32 v77, v154, v155
  v_cvt_pk_bf16_f32 v78, v156, v157
  v_cvt_pk_bf16_f32 v79, v158, v159
  v_and_b32 v24, 31, v2
  v_lshlrev_b32 v24, 11, v24
  v_lshrrev_b32 v25, 5, v2
  v_lshl_add_u32 v24, v25, 4, v24
  s_lshl_b32 s80, s30, 2
  s_add_u32 s80, s80, s29
  s_lshl_b32 s80, s80, 16
  s_lshl_b32 s81, s28, 10
  s_add_u32 s80, s80, s81
  s_lshl_b32 s81, s31, 8
  s_add_u32 s80, s80, s81
  s_lshl_b32 s81, s34, 7
  s_add_u32 s80, s80, s81
  buffer_store_dwordx4 v[64:67], v24, s[68:71], s80 offen offset:0
  buffer_store_dwordx4 v[68:71], v24, s[68:71], s80 offen offset:32
  buffer_store_dwordx4 v[72:75], v24, s[68:71], s80 offen offset:64
  buffer_store_dwordx4 v[76:79], v24, s[68:71], s80 offen offset:96
C_FIN:
  s_endpgm
PRODUCER:
  s_sub_u32 s34, s33, 8
  s_setprio 3
  v_lshrrev_b32 v20, 3, v2
  v_bfe_u32 v21, v2, 4, 1
  v_lshlrev_b32 v21, 2, v21
  v_and_b32 v22, 7, v2
  v_xor_b32 v22, v22, v21
  v_lshlrev_b32 v20, 12, v20
  v_xor_b32 v23, 0, v22
  v_lshl_add_u32 v4, v23, 4, v20
  v_xor_b32 v23, 1, v22
  v_lshl_add_u32 v5, v23, 4, v20
  v_xor_b32 v23, 2, v22
  v_lshl_add_u32 v6, v23, 4, v20
  v_xor_b32 v23, 3, v22
  v_lshl_add_u32 v7, v23, 4, v20
  v_lshrrev_b32 v20, 4, v2
  v_lshlrev_b32 v21, 2, v20
  v_and_b32 v22, 15, v2
  v_xor_b32 v22, v22, v21
  v_lshlrev_b32 v22, 4, v22
  v_lshl_add_u32 v8, v20, 13, v22
  v_add_u32 v9, 31744, v8
  v_add_u32 v10, 63488, v8
  v_add_u32 v11, 95232, v8
  s_lshl_b32 s3, s30, 2
  s_add_u32 s3, s3, s34
  s_lshl_b32 s32, s3, 5
  s_lshl_b32 s3, s3, 15
  s_lshl_b32 s80, s29, 3
  s_lshl_b32 s81, s31, 1
  s_add_u32 s80, s80, s81
  s_add_u32 s32, s32, s80
  s_lshl_b32 s32, s32, 13
  s_lshr_b32 s81, s34, 1
  s_add_u32 s80, s80, s81
  s_lshl_b32 s80, s80, 8
  s_and_b32 s27, s34, 1
  s_lshl_b32 s27, s27, 18
  s_add_u32 s27, s27, s80
  s_waitcnt lgkmcnt(0)
  s_cmp_eq_u32 s28, 0
  s_cselect_b32 s8, s8, s16
  s_cselect_b32 s9, s9, s17
  s_cselect_b32 s14, s14, s22
  s_cselect_b32 s15, s15, s23
  s_mov_b32 s36, s8
  s_mov_b32 s37, s9
  s_mov_b32 s38, 0x100000
  s_mov_b32 s39, 0x00020000
  s_mov_b32 s40, s14
  s_mov_b32 s41, s15
  s_mov_b32 s42, 0x400000
  s_mov_b32 s43, 0x00020000
  s_lshl_b32 s9, s34, 12
  s_lshl_b32 s8, s34, 13
  s_add_u32 s80, s35, 0
  s_and_b32 s80, s80, 7
  s_lshl_b32 s81, s80, 19
  s_add_u32 s81, s81, s27
  s_add_u32 m0, s8, 16384
  s_nop 0
  buffer_load_dwordx4 v8, s[40:43], s81 offen offset:0  lds
  buffer_load_dwordx4 v9, s[40:43], s81 offen offset:1024  lds
  buffer_load_dwordx4 v10, s[40:43], s81 offen offset:2048  lds
  buffer_load_dwordx4 v11, s[40:43], s81 offen offset:3072  lds
  s_add_u32 m0, s8, 20480
  s_add_u32 s81, s81, 131072
  buffer_load_dwordx4 v8, s[40:43], s81 offen offset:0  lds
  buffer_load_dwordx4 v9, s[40:43], s81 offen offset:1024  lds
  buffer_load_dwordx4 v10, s[40:43], s81 offen offset:2048  lds
  buffer_load_dwordx4 v11, s[40:43], s81 offen offset:3072  lds
  s_add_u32 m0, s9, 0
  s_lshl_b32 s80, s80, 7
  s_add_u32 s80, s80, s3
  buffer_load_dwordx4 v4, s[36:39], s80 offen offset:0  lds
  buffer_load_dwordx4 v5, s[36:39], s80 offen offset:1024  lds
  buffer_load_dwordx4 v6, s[36:39], s80 offen offset:2048  lds
  buffer_load_dwordx4 v7, s[36:39], s80 offen offset:3072  lds
  s_cmp_eq_u32 s28, 0
  s_cselect_b32 s10, s10, s18
  s_cselect_b32 s11, s11, s19
  s_cselect_b32 s12, s12, s20
  s_cselect_b32 s13, s13, s21
  s_cselect_b32 s72, s72, s74
  s_cselect_b32 s73, s73, s75
  s_mov_b32 s44, s10
  s_mov_b32 s45, s11
  s_mov_b32 s46, 0x800000
  s_mov_b32 s47, 0x00020000
  s_mov_b32 s48, s12
  s_mov_b32 s49, s13
  s_mov_b32 s50, 0x800000
  s_mov_b32 s51, 0x00020000
  s_add_u32 s80, s24, 0
  s_addc_u32 s81, s25, 0
  s_mov_b32 s52, s80
  s_mov_b32 s53, s81
  s_mov_b32 s54, 0x1000000
  s_mov_b32 s55, 0x00020000
  s_add_u32 s80, s24, 33554432
  s_addc_u32 s81, s25, 0
  s_mov_b32 s64, s80
  s_mov_b32 s65, s81
  s_mov_b32 s66, 0x10000
  s_mov_b32 s67, 0x00020000
  s_mov_b32 s56, s72
  s_mov_b32 s57, s73
  s_mov_b32 s58, 0x400000
  s_mov_b32 s59, 0x00020000
  s_mov_b32 s76, s6
  s_mov_b32 s77, s7
  s_mov_b32 s78, 0x100
  s_mov_b32 s79, 0x00020000
  v_lshl_add_u32 v12, v20, 10, v22
  v_add_u32 v13, 3072, v12
  v_add_u32 v14, 6144, v12
  v_add_u32 v15, 9216, v12
  v_lshl_add_u32 v17, v20, 8, v22
  v_and_b32 v22, 15, v2
  v_xor_b32 v22, v22, v20
  v_lshlrev_b32 v22, 4, v22
  v_lshl_add_u32 v16, v20, 8, v22
  s_add_u32 s80, s24, 16777216
  s_addc_u32 s81, s25, 0
  s_mov_b32 s60, s80
  s_mov_b32 s61, s81
  s_mov_b32 s62, 0x1000000
  s_mov_b32 s63, 0x00020000
  s_mov_b32 s68, s4
  s_mov_b32 s69, s5
  s_mov_b32 s70, 0x200000
  s_mov_b32 s71, 0x00020000
  s_cmp_lg_u32 s34, 3
  s_cbranch_scc1 Ltlb_9
  v_mov_b32 v22, 0
  s_mov_b64 exec, 1
  buffer_load_dword v23, v22, s[48:51], s32 offen
  buffer_load_dword v23, v22, s[44:47], s32 offen
  s_mov_b32 s80, 0x200000
  buffer_load_dword v23, v22, s[40:43], 0 offen
  buffer_load_dword v23, v22, s[40:43], s80 offen
  s_lshl_b32 s80, s29, 20
  buffer_load_dword v23, v22, s[56:59], s80 offen
  s_lshl_b32 s80, s26, 21
  buffer_load_dword v23, v22, s[52:55], s80 offen sc1
  s_lshl_b32 s80, s28, 3
  s_add_u32 s80, s80, s30
  s_lshl_b32 s80, s80, 2
  s_add_u32 s80, s80, s31
  s_lshl_b32 s80, s80, 17
  buffer_load_dword v23, v22, s[60:63], s80 offen sc1
  buffer_load_dword v23, v22, s[68:71], 0 offen
  buffer_load_dword v23, v22, s[64:67], 0 offen sc1
  buffer_load_dword v23, v22, s[76:79], 0 offen sc1
  s_mov_b64 exec, -1
Ltlb_9:
  s_barrier
  s_add_u32 s80, s35, 1
  s_and_b32 s80, s80, 7
  s_lshl_b32 s81, s80, 19
  s_add_u32 s81, s81, s27
  s_add_u32 m0, s8, 65536
  s_nop 0
  buffer_load_dwordx4 v8, s[40:43], s81 offen offset:0  lds
  buffer_load_dwordx4 v9, s[40:43], s81 offen offset:1024  lds
  buffer_load_dwordx4 v10, s[40:43], s81 offen offset:2048  lds
  buffer_load_dwordx4 v11, s[40:43], s81 offen offset:3072  lds
  s_add_u32 m0, s8, 69632
  s_add_u32 s81, s81, 131072
  buffer_load_dwordx4 v8, s[40:43], s81 offen offset:0  lds
  buffer_load_dwordx4 v9, s[40:43], s81 offen offset:1024  lds
  buffer_load_dwordx4 v10, s[40:43], s81 offen offset:2048  lds
  buffer_load_dwordx4 v11, s[40:43], s81 offen offset:3072  lds
  s_add_u32 m0, s9, 49152
  s_lshl_b32 s80, s80, 7
  s_add_u32 s80, s80, s3
  buffer_load_dwordx4 v4, s[36:39], s80 offen offset:0  lds
  buffer_load_dwordx4 v5, s[36:39], s80 offen offset:1024  lds
  buffer_load_dwordx4 v6, s[36:39], s80 offen offset:2048  lds
  buffer_load_dwordx4 v7, s[36:39], s80 offen offset:3072  lds
  s_cmp_lg_u32 s2, 0
  s_cbranch_scc1 Lnl_10
  s_cmp_lg_u32 s34, 0
  s_cbranch_scc1 Lnl_10
  s_memrealtime s[84:85]
  s_waitcnt lgkmcnt(0)
  s_or_b32 s84, s84, 1
  v_mov_b32 v24, s84
  v_mov_b32 v25, s85
  v_mov_b32 v26, 0
  s_mov_b64 exec, 1
  buffer_store_dwordx2 v[24:25], v26, s[76:79], 0 offen sc1
  s_mov_b64 exec, -1
Lnl_10:
  s_add_u32 s80, s30, s31
  s_and_b32 s80, s80, 1
  s_cmp_eq_u32 s80, 0
  s_cbranch_scc0 P1_B
  s_add_u32 s80, s32, 0
  s_add_u32 s81, s80, 4096
  buffer_load_dwordx4 v[32:35], v3, s[44:47], s80 offen offset:0 nt
  buffer_load_dwordx4 v[36:39], v3, s[44:47], s80 offen offset:1024 nt
  buffer_load_dwordx4 v[40:43], v3, s[44:47], s80 offen offset:2048 nt
  buffer_load_dwordx4 v[44:47], v3, s[44:47], s80 offen offset:3072 nt
  buffer_load_dwordx4 v[48:51], v3, s[44:47], s81 offen offset:0 nt
  buffer_load_dwordx4 v[52:55], v3, s[44:47], s81 offen offset:1024 nt
  buffer_load_dwordx4 v[56:59], v3, s[44:47], s81 offen offset:2048 nt
  buffer_load_dwordx4 v[60:63], v3, s[44:47], s81 offen offset:3072 nt
  s_waitcnt vmcnt(20)
  s_barrier
  s_add_u32 s80, s35, 2
  s_and_b32 s80, s80, 7
  s_lshl_b32 s81, s80, 19
  s_add_u32 s81, s81, s27
  s_add_u32 m0, s8, 114688
  s_nop 0
  buffer_load_dwordx4 v8, s[40:43], s81 offen offset:0  lds
  buffer_load_dwordx4 v9, s[40:43], s81 offen offset:1024  lds
  buffer_load_dwordx4 v10, s[40:43], s81 offen offset:2048  lds
  buffer_load_dwordx4 v11, s[40:43], s81 offen offset:3072  lds
  s_add_u32 m0, s8, 118784
  s_add_u32 s81, s81, 131072
  buffer_load_dwordx4 v8, s[40:43], s81 offen offset:0  lds
  buffer_load_dwordx4 v9, s[40:43], s81 offen offset:1024  lds
  buffer_load_dwordx4 v10, s[40:43], s81 offen offset:2048  lds
  buffer_load_dwordx4 v11, s[40:43], s81 offen offset:3072  lds
  s_add_u32 m0, s9, 98304
  s_lshl_b32 s80, s80, 7
  s_add_u32 s80, s80, s3
  buffer_load_dwordx4 v4, s[36:39], s80 offen offset:0  lds
  buffer_load_dwordx4 v5, s[36:39], s80 offen offset:1024  lds
  buffer_load_dwordx4 v6, s[36:39], s80 offen offset:2048  lds
  buffer_load_dwordx4 v7, s[36:39], s80 offen offset:3072  lds
  s_add_u32 s80, s32, 8192
  s_add_u32 s81, s80, 4096
  buffer_load_dwordx4 v[64:67], v3, s[44:47], s80 offen offset:0 nt
  buffer_load_dwordx4 v[68:71], v3, s[44:47], s80 offen offset:1024 nt
  buffer_load_dwordx4 v[72:75], v3, s[44:47], s80 offen offset:2048 nt
  buffer_load_dwordx4 v[76:79], v3, s[44:47], s80 offen offset:3072 nt
  buffer_load_dwordx4 v[80:83], v3, s[44:47], s81 offen offset:0 nt
  buffer_load_dwordx4 v[84:87], v3, s[44:47], s81 offen offset:1024 nt
  buffer_load_dwordx4 v[88:91], v3, s[44:47], s81 offen offset:2048 nt
  buffer_load_dwordx4 v[92:95], v3, s[44:47], s81 offen offset:3072 nt
  s_waitcnt vmcnt(28)
  s_barrier
  s_add_u32 s80, s35, 3
  s_and_b32 s80, s80, 7
  s_lshl_b32 s81, s80, 19
  s_add_u32 s81, s81, s27
  s_add_u32 m0, s8, 16384
  s_nop 0
  buffer_load_dwordx4 v8, s[40:43], s81 offen offset:0  lds
  buffer_load_dwordx4 v9, s[40:43], s81 offen offset:1024  lds
  buffer_load_dwordx4 v10, s[40:43], s81 offen offset:2048  lds
  buffer_load_dwordx4 v11, s[40:43], s81 offen offset:3072  lds
  s_add_u32 m0, s8, 20480
  s_add_u32 s81, s81, 131072
  buffer_load_dwordx4 v8, s[40:43], s81 offen offset:0  lds
  buffer_load_dwordx4 v9, s[40:43], s81 offen offset:1024  lds
  buffer_load_dwordx4 v10, s[40:43], s81 offen offset:2048  lds
  buffer_load_dwordx4 v11, s[40:43], s81 offen offset:3072  lds
  s_add_u32 m0, s9, 0
  s_lshl_b32 s80, s80, 7
  s_add_u32 s80, s80, s3
  buffer_load_dwordx4 v4, s[36:39], s80 offen offset:0  lds
  buffer_load_dwordx4 v5, s[36:39], s80 offen offset:1024  lds
  buffer_load_dwordx4 v6, s[36:39], s80 offen offset:2048  lds
  buffer_load_dwordx4 v7, s[36:39], s80 offen offset:3072  lds
  s_add_u32 s80, s32, 0
  s_add_u32 s81, s80, 4096
  buffer_load_dwordx4 v[96:99], v3, s[48:51], s80 offen offset:0 nt
  buffer_load_dwordx4 v[100:103], v3, s[48:51], s80 offen offset:1024 nt
  buffer_load_dwordx4 v[104:107], v3, s[48:51], s80 offen offset:2048 nt
  buffer_load_dwordx4 v[108:111], v3, s[48:51], s80 offen offset:3072 nt
  buffer_load_dwordx4 v[112:115], v3, s[48:51], s81 offen offset:0 nt
  buffer_load_dwordx4 v[116:119], v3, s[48:51], s81 offen offset:1024 nt
  buffer_load_dwordx4 v[120:123], v3, s[48:51], s81 offen offset:2048 nt
  buffer_load_dwordx4 v[124:127], v3, s[48:51], s81 offen offset:3072 nt
  s_waitcnt vmcnt(28)
  s_barrier
  s_add_u32 s80, s35, 4
  s_and_b32 s80, s80, 7
  s_lshl_b32 s81, s80, 19
  s_add_u32 s81, s81, s27
  s_add_u32 m0, s8, 65536
  s_nop 0
  buffer_load_dwordx4 v8, s[40:43], s81 offen offset:0  lds
  buffer_load_dwordx4 v9, s[40:43], s81 offen offset:1024  lds
  buffer_load_dwordx4 v10, s[40:43], s81 offen offset:2048  lds
  buffer_load_dwordx4 v11, s[40:43], s81 offen offset:3072  lds
  s_add_u32 m0, s8, 69632
  s_add_u32 s81, s81, 131072
  buffer_load_dwordx4 v8, s[40:43], s81 offen offset:0  lds
  buffer_load_dwordx4 v9, s[40:43], s81 offen offset:1024  lds
  buffer_load_dwordx4 v10, s[40:43], s81 offen offset:2048  lds
  buffer_load_dwordx4 v11, s[40:43], s81 offen offset:3072  lds
  s_add_u32 m0, s9, 49152
  s_lshl_b32 s80, s80, 7
  s_add_u32 s80, s80, s3
  buffer_load_dwordx4 v4, s[36:39], s80 offen offset:0  lds
  buffer_load_dwordx4 v5, s[36:39], s80 offen offset:1024  lds
  buffer_load_dwordx4 v6, s[36:39], s80 offen offset:2048  lds
  buffer_load_dwordx4 v7, s[36:39], s80 offen offset:3072  lds
  s_waitcnt vmcnt(20)
  s_barrier
  s_add_u32 s80, s35, 5
  s_and_b32 s80, s80, 7
  s_lshl_b32 s81, s80, 19
  s_add_u32 s81, s81, s27
  s_add_u32 m0, s8, 114688
  s_nop 0
  buffer_load_dwordx4 v8, s[40:43], s81 offen offset:0  lds
  buffer_load_dwordx4 v9, s[40:43], s81 offen offset:1024  lds
  buffer_load_dwordx4 v10, s[40:43], s81 offen offset:2048  lds
  buffer_load_dwordx4 v11, s[40:43], s81 offen offset:3072  lds
  s_add_u32 m0, s8, 118784
  s_add_u32 s81, s81, 131072
  buffer_load_dwordx4 v8, s[40:43], s81 offen offset:0  lds
  buffer_load_dwordx4 v9, s[40:43], s81 offen offset:1024  lds
  buffer_load_dwordx4 v10, s[40:43], s81 offen offset:2048  lds
  buffer_load_dwordx4 v11, s[40:43], s81 offen offset:3072  lds
  s_add_u32 m0, s9, 98304
  s_lshl_b32 s80, s80, 7
  s_add_u32 s80, s80, s3
  buffer_load_dwordx4 v4, s[36:39], s80 offen offset:0  lds
  buffer_load_dwordx4 v5, s[36:39], s80 offen offset:1024  lds
  buffer_load_dwordx4 v6, s[36:39], s80 offen offset:2048  lds
  buffer_load_dwordx4 v7, s[36:39], s80 offen offset:3072  lds
  s_add_u32 s80, s32, 8192
  s_add_u32 s81, s80, 4096
  buffer_load_dwordx4 v[128:131], v3, s[48:51], s80 offen offset:0 nt
  buffer_load_dwordx4 v[132:135], v3, s[48:51], s80 offen offset:1024 nt
  buffer_load_dwordx4 v[136:139], v3, s[48:51], s80 offen offset:2048 nt
  buffer_load_dwordx4 v[140:143], v3, s[48:51], s80 offen offset:3072 nt
  buffer_load_dwordx4 v[144:147], v3, s[48:51], s81 offen offset:0 nt
  buffer_load_dwordx4 v[148:151], v3, s[48:51], s81 offen offset:1024 nt
  buffer_load_dwordx4 v[152:155], v3, s[48:51], s81 offen offset:2048 nt
  buffer_load_dwordx4 v[156:159], v3, s[48:51], s81 offen offset:3072 nt
  s_waitcnt vmcnt(20)
  s_barrier
  s_add_u32 s80, s35, 6
  s_and_b32 s80, s80, 7
  s_lshl_b32 s81, s80, 19
  s_add_u32 s81, s81, s27
  s_add_u32 m0, s8, 16384
  s_nop 0
  buffer_load_dwordx4 v8, s[40:43], s81 offen offset:0  lds
  buffer_load_dwordx4 v9, s[40:43], s81 offen offset:1024  lds
  buffer_load_dwordx4 v10, s[40:43], s81 offen offset:2048  lds
  buffer_load_dwordx4 v11, s[40:43], s81 offen offset:3072  lds
  s_add_u32 m0, s8, 20480
  s_add_u32 s81, s81, 131072
  buffer_load_dwordx4 v8, s[40:43], s81 offen offset:0  lds
  buffer_load_dwordx4 v9, s[40:43], s81 offen offset:1024  lds
  buffer_load_dwordx4 v10, s[40:43], s81 offen offset:2048  lds
  buffer_load_dwordx4 v11, s[40:43], s81 offen offset:3072  lds
  s_add_u32 m0, s9, 0
  s_lshl_b32 s80, s80, 7
  s_add_u32 s80, s80, s3
  buffer_load_dwordx4 v4, s[36:39], s80 offen offset:0  lds
  buffer_load_dwordx4 v5, s[36:39], s80 offen offset:1024  lds
  buffer_load_dwordx4 v6, s[36:39], s80 offen offset:2048  lds
  buffer_load_dwordx4 v7, s[36:39], s80 offen offset:3072  lds
  s_waitcnt vmcnt(20)
  s_barrier
  s_add_u32 s80, s35, 7
  s_and_b32 s80, s80, 7
  s_lshl_b32 s81, s80, 19
  s_add_u32 s81, s81, s27
  s_add_u32 m0, s8, 65536
  s_nop 0
  buffer_load_dwordx4 v8, s[40:43], s81 offen offset:0  lds
  buffer_load_dwordx4 v9, s[40:43], s81 offen offset:1024  lds
  buffer_load_dwordx4 v10, s[40:43], s81 offen offset:2048  lds
  buffer_load_dwordx4 v11, s[40:43], s81 offen offset:3072  lds
  s_add_u32 m0, s8, 69632
  s_add_u32 s81, s81, 131072
  buffer_load_dwordx4 v8, s[40:43], s81 offen offset:0  lds
  buffer_load_dwordx4 v9, s[40:43], s81 offen offset:1024  lds
  buffer_load_dwordx4 v10, s[40:43], s81 offen offset:2048  lds
  buffer_load_dwordx4 v11, s[40:43], s81 offen offset:3072  lds
  s_add_u32 m0, s9, 49152
  s_lshl_b32 s80, s80, 7
  s_add_u32 s80, s80, s3
  buffer_load_dwordx4 v4, s[36:39], s80 offen offset:0  lds
  buffer_load_dwordx4 v5, s[36:39], s80 offen offset:1024  lds
  buffer_load_dwordx4 v6, s[36:39], s80 offen offset:2048  lds
  buffer_load_dwordx4 v7, s[36:39], s80 offen offset:3072  lds
  s_lshl_b32 s80, s29, 10
  s_lshl_b32 s81, s30, 7
  s_add_u32 s80, s80, s81
  s_lshl_b32 s81, s34, 5
  s_add_u32 s80, s80, s81
  s_lshl_b32 s80, s80, 10
  s_lshl_b32 s81, s31, 8
  s_add_u32 s80, s80, s81
  v_lshrrev_b32 v24, 1, v2
  v_lshlrev_b32 v24, 10, v24
  v_and_b32 v25, 1, v2
  v_lshl_add_u32 v24, v25, 7, v24
  buffer_load_dword v23, v24, s[56:59], s80 offen
  v_mov_b32 v28, 0
  buffer_load_dwordx2 v[30:31], v28, s[76:79], 0 offen sc1
  s_waitcnt vmcnt(14)
  s_barrier
  s_setprio 0
  s_add_u32 s80, s8, 98304
  v_xor_b32 v24, 0, v16
  v_add_u32 v24, s80, v24
  v_xor_b32 v25, 64, v16
  v_add_u32 v25, s80, v25
  v_xor_b32 v26, 128, v16
  v_add_u32 v26, s80, v26
  v_xor_b32 v27, 192, v16
  v_add_u32 v27, s80, v27
  ds_write_b128 v24, v[32:35] offset:0
  ds_write_b128 v25, v[36:39] offset:1024
  ds_write_b128 v26, v[40:43] offset:2048
  ds_write_b128 v27, v[44:47] offset:3072
  ds_write_b128 v24, v[48:51] offset:4096
  ds_write_b128 v25, v[52:55] offset:5120
  ds_write_b128 v26, v[56:59] offset:6144
  ds_write_b128 v27, v[60:63] offset:7168
  s_waitcnt vmcnt(2)
  s_barrier
  s_waitcnt lgkmcnt(0)
  s_add_u32 s80, s8, 131072
  v_xor_b32 v24, 0, v16
  v_add_u32 v24, s80, v24
  v_xor_b32 v25, 64, v16
  v_add_u32 v25, s80, v25
  v_xor_b32 v26, 128, v16
  v_add_u32 v26, s80, v26
  v_xor_b32 v27, 192, v16
  v_add_u32 v27, s80, v27
  ds_write_b128 v24, v[64:67] offset:0
  ds_write_b128 v25, v[68:71] offset:1024
  ds_write_b128 v26, v[72:75] offset:2048
  ds_write_b128 v27, v[76:79] offset:3072
  ds_write_b128 v24, v[80:83] offset:4096
  ds_write_b128 v25, v[84:87] offset:5120
  ds_write_b128 v26, v[88:91] offset:6144
  ds_write_b128 v27, v[92:95] offset:7168
  s_waitcnt lgkmcnt(0)
  v_add_u32 v24, s8, v17
  ds_write_b128 v24, v[96:99] offset:0
  ds_write_b128 v24, v[100:103] offset:1024
  ds_write_b128 v24, v[104:107] offset:2048
  ds_write_b128 v24, v[108:111] offset:3072
  ds_write_b128 v24, v[112:115] offset:4096
  ds_write_b128 v24, v[116:119] offset:5120
  ds_write_b128 v24, v[120:123] offset:6144
  ds_write_b128 v24, v[124:127] offset:7168
  s_waitcnt lgkmcnt(0)
  s_branch P1_J
P1_B:
  s_waitcnt vmcnt(12)
  s_barrier
  s_add_u32 s80, s35, 2
  s_and_b32 s80, s80, 7
  s_lshl_b32 s81, s80, 19
  s_add_u32 s81, s81, s27
  s_add_u32 m0, s8, 114688
  s_nop 0
  buffer_load_dwordx4 v8, s[40:43], s81 offen offset:0  lds
  buffer_load_dwordx4 v9, s[40:43], s81 offen offset:1024  lds
  buffer_load_dwordx4 v10, s[40:43], s81 offen offset:2048  lds
  buffer_load_dwordx4 v11, s[40:43], s81 offen offset:3072  lds
  s_add_u32 m0, s8, 118784
  s_add_u32 s81, s81, 131072
  buffer_load_dwordx4 v8, s[40:43], s81 offen offset:0  lds
  buffer_load_dwordx4 v9, s[40:43], s81 offen offset:1024  lds
  buffer_load_dwordx4 v10, s[40:43], s81 offen offset:2048  lds
  buffer_load_dwordx4 v11, s[40:43], s81 offen offset:3072  lds
  s_add_u32 m0, s9, 98304
  s_lshl_b32 s80, s80, 7
  s_add_u32 s80, s80, s3
  buffer_load_dwordx4 v4, s[36:39], s80 offen offset:0  lds
  buffer_load_dwordx4 v5, s[36:39], s80 offen offset:1024  lds
  buffer_load_dwordx4 v6, s[36:39], s80 offen offset:2048  lds
  buffer_load_dwordx4 v7, s[36:39], s80 offen offset:3072  lds
  s_add_u32 s80, s32, 0
  s_add_u32 s81, s80, 4096
  buffer_load_dwordx4 v[32:35], v3, s[44:47], s80 offen offset:0 nt
  buffer_load_dwordx4 v[36:39], v3, s[44:47], s80 offen offset:1024 nt
  buffer_load_dwordx4 v[40:43], v3, s[44:47], s80 offen offset:2048 nt
  buffer_load_dwordx4 v[44:47], v3, s[44:47], s80 offen offset:3072 nt
  buffer_load_dwordx4 v[48:51], v3, s[44:47], s81 offen offset:0 nt
  buffer_load_dwordx4 v[52:55], v3, s[44:47], s81 offen offset:1024 nt
  buffer_load_dwordx4 v[56:59], v3, s[44:47], s81 offen offset:2048 nt
  buffer_load_dwordx4 v[60:63], v3, s[44:47], s81 offen offset:3072 nt
  s_waitcnt vmcnt(20)
  s_barrier
  s_add_u32 s80, s35, 3
  s_and_b32 s80, s80, 7
  s_lshl_b32 s81, s80, 19
  s_add_u32 s81, s81, s27
  s_add_u32 m0, s8, 16384
  s_nop 0
  buffer_load_dwordx4 v8, s[40:43], s81 offen offset:0  lds
  buffer_load_dwordx4 v9, s[40:43], s81 offen offset:1024  lds
  buffer_load_dwordx4 v10, s[40:43], s81 offen offset:2048  lds
  buffer_load_dwordx4 v11, s[40:43], s81 offen offset:3072  lds
  s_add_u32 m0, s8, 20480
  s_add_u32 s81, s81, 131072
  buffer_load_dwordx4 v8, s[40:43], s81 offen offset:0  lds
  buffer_load_dwordx4 v9, s[40:43], s81 offen offset:1024  lds
  buffer_load_dwordx4 v10, s[40:43], s81 offen offset:2048  lds
  buffer_load_dwordx4 v11, s[40:43], s81 offen offset:3072  lds
  s_add_u32 m0, s9, 0
  s_lshl_b32 s80, s80, 7
  s_add_u32 s80, s80, s3
  buffer_load_dwordx4 v4, s[36:39], s80 offen offset:0  lds
  buffer_load_dwordx4 v5, s[36:39], s80 offen offset:1024  lds
  buffer_load_dwordx4 v6, s[36:39], s80 offen offset:2048  lds
  buffer_load_dwordx4 v7, s[36:39], s80 offen offset:3072  lds
  s_add_u32 s80, s32, 8192
  s_add_u32 s81, s80, 4096
  buffer_load_dwordx4 v[64:67], v3, s[44:47], s80 offen offset:0 nt
  buffer_load_dwordx4 v[68:71], v3, s[44:47], s80 offen offset:1024 nt
  buffer_load_dwordx4 v[72:75], v3, s[44:47], s80 offen offset:2048 nt
  buffer_load_dwordx4 v[76:79], v3, s[44:47], s80 offen offset:3072 nt
  buffer_load_dwordx4 v[80:83], v3, s[44:47], s81 offen offset:0 nt
  buffer_load_dwordx4 v[84:87], v3, s[44:47], s81 offen offset:1024 nt
  buffer_load_dwordx4 v[88:91], v3, s[44:47], s81 offen offset:2048 nt
  buffer_load_dwordx4 v[92:95], v3, s[44:47], s81 offen offset:3072 nt
  s_waitcnt vmcnt(28)
  s_barrier
  s_add_u32 s80, s35, 4
  s_and_b32 s80, s80, 7
  s_lshl_b32 s81, s80, 19
  s_add_u32 s81, s81, s27
  s_add_u32 m0, s8, 65536
  s_nop 0
  buffer_load_dwordx4 v8, s[40:43], s81 offen offset:0  lds
  buffer_load_dwordx4 v9, s[40:43], s81 offen offset:1024  lds
  buffer_load_dwordx4 v10, s[40:43], s81 offen offset:2048  lds
  buffer_load_dwordx4 v11, s[40:43], s81 offen offset:3072  lds
  s_add_u32 m0, s8, 69632
  s_add_u32 s81, s81, 131072
  buffer_load_dwordx4 v8, s[40:43], s81 offen offset:0  lds
  buffer_load_dwordx4 v9, s[40:43], s81 offen offset:1024  lds
  buffer_load_dwordx4 v10, s[40:43], s81 offen offset:2048  lds
  buffer_load_dwordx4 v11, s[40:43], s81 offen offset:3072  lds
  s_add_u32 m0, s9, 49152
  s_lshl_b32 s80, s80, 7
  s_add_u32 s80, s80, s3
  buffer_load_dwordx4 v4, s[36:39], s80 offen offset:0  lds
  buffer_load_dwordx4 v5, s[36:39], s80 offen offset:1024  lds
  buffer_load_dwordx4 v6, s[36:39], s80 offen offset:2048  lds
  buffer_load_dwordx4 v7, s[36:39], s80 offen offset:3072  lds
  s_add_u32 s80, s32, 0
  s_add_u32 s81, s80, 4096
  buffer_load_dwordx4 v[96:99], v3, s[48:51], s80 offen offset:0 nt
  buffer_load_dwordx4 v[100:103], v3, s[48:51], s80 offen offset:1024 nt
  buffer_load_dwordx4 v[104:107], v3, s[48:51], s80 offen offset:2048 nt
  buffer_load_dwordx4 v[108:111], v3, s[48:51], s80 offen offset:3072 nt
  buffer_load_dwordx4 v[112:115], v3, s[48:51], s81 offen offset:0 nt
  buffer_load_dwordx4 v[116:119], v3, s[48:51], s81 offen offset:1024 nt
  buffer_load_dwordx4 v[120:123], v3, s[48:51], s81 offen offset:2048 nt
  buffer_load_dwordx4 v[124:127], v3, s[48:51], s81 offen offset:3072 nt
  s_waitcnt vmcnt(28)
  s_barrier
  s_add_u32 s80, s35, 5
  s_and_b32 s80, s80, 7
  s_lshl_b32 s81, s80, 19
  s_add_u32 s81, s81, s27
  s_add_u32 m0, s8, 114688
  s_nop 0
  buffer_load_dwordx4 v8, s[40:43], s81 offen offset:0  lds
  buffer_load_dwordx4 v9, s[40:43], s81 offen offset:1024  lds
  buffer_load_dwordx4 v10, s[40:43], s81 offen offset:2048  lds
  buffer_load_dwordx4 v11, s[40:43], s81 offen offset:3072  lds
  s_add_u32 m0, s8, 118784
  s_add_u32 s81, s81, 131072
  buffer_load_dwordx4 v8, s[40:43], s81 offen offset:0  lds
  buffer_load_dwordx4 v9, s[40:43], s81 offen offset:1024  lds
  buffer_load_dwordx4 v10, s[40:43], s81 offen offset:2048  lds
  buffer_load_dwordx4 v11, s[40:43], s81 offen offset:3072  lds
  s_add_u32 m0, s9, 98304
  s_lshl_b32 s80, s80, 7
  s_add_u32 s80, s80, s3
  buffer_load_dwordx4 v4, s[36:39], s80 offen offset:0  lds
  buffer_load_dwordx4 v5, s[36:39], s80 offen offset:1024  lds
  buffer_load_dwordx4 v6, s[36:39], s80 offen offset:2048  lds
  buffer_load_dwordx4 v7, s[36:39], s80 offen offset:3072  lds
  s_waitcnt vmcnt(20)
  s_barrier
  s_add_u32 s80, s35, 6
  s_and_b32 s80, s80, 7
  s_lshl_b32 s81, s80, 19
  s_add_u32 s81, s81, s27
  s_add_u32 m0, s8, 16384
  s_nop 0
  buffer_load_dwordx4 v8, s[40:43], s81 offen offset:0  lds
  buffer_load_dwordx4 v9, s[40:43], s81 offen offset:1024  lds
  buffer_load_dwordx4 v10, s[40:43], s81 offen offset:2048  lds
  buffer_load_dwordx4 v11, s[40:43], s81 offen offset:3072  lds
  s_add_u32 m0, s8, 20480
  s_add_u32 s81, s81, 131072
  buffer_load_dwordx4 v8, s[40:43], s81 offen offset:0  lds
  buffer_load_dwordx4 v9, s[40:43], s81 offen offset:1024  lds
  buffer_load_dwordx4 v10, s[40:43], s81 offen offset:2048  lds
  buffer_load_dwordx4 v11, s[40:43], s81 offen offset:3072  lds
  s_add_u32 m0, s9, 0
  s_lshl_b32 s80, s80, 7
  s_add_u32 s80, s80, s3
  buffer_load_dwordx4 v4, s[36:39], s80 offen offset:0  lds
  buffer_load_dwordx4 v5, s[36:39], s80 offen offset:1024  lds
  buffer_load_dwordx4 v6, s[36:39], s80 offen offset:2048  lds
  buffer_load_dwordx4 v7, s[36:39], s80 offen offset:3072  lds
  s_add_u32 s80, s32, 8192
  s_add_u32 s81, s80, 4096
  buffer_load_dwordx4 v[128:131], v3, s[48:51], s80 offen offset:0 nt
  buffer_load_dwordx4 v[132:135], v3, s[48:51], s80 offen offset:1024 nt
  buffer_load_dwordx4 v[136:139], v3, s[48:51], s80 offen offset:2048 nt
  buffer_load_dwordx4 v[140:143], v3, s[48:51], s80 offen offset:3072 nt
  buffer_load_dwordx4 v[144:147], v3, s[48:51], s81 offen offset:0 nt
  buffer_load_dwordx4 v[148:151], v3, s[48:51], s81 offen offset:1024 nt
  buffer_load_dwordx4 v[152:155], v3, s[48:51], s81 offen offset:2048 nt
  buffer_load_dwordx4 v[156:159], v3, s[48:51], s81 offen offset:3072 nt
  s_waitcnt vmcnt(20)
  s_barrier
  s_add_u32 s80, s35, 7
  s_and_b32 s80, s80, 7
  s_lshl_b32 s81, s80, 19
  s_add_u32 s81, s81, s27
  s_add_u32 m0, s8, 65536
  s_nop 0
  buffer_load_dwordx4 v8, s[40:43], s81 offen offset:0  lds
  buffer_load_dwordx4 v9, s[40:43], s81 offen offset:1024  lds
  buffer_load_dwordx4 v10, s[40:43], s81 offen offset:2048  lds
  buffer_load_dwordx4 v11, s[40:43], s81 offen offset:3072  lds
  s_add_u32 m0, s8, 69632
  s_add_u32 s81, s81, 131072
  buffer_load_dwordx4 v8, s[40:43], s81 offen offset:0  lds
  buffer_load_dwordx4 v9, s[40:43], s81 offen offset:1024  lds
  buffer_load_dwordx4 v10, s[40:43], s81 offen offset:2048  lds
  buffer_load_dwordx4 v11, s[40:43], s81 offen offset:3072  lds
  s_add_u32 m0, s9, 49152
  s_lshl_b32 s80, s80, 7
  s_add_u32 s80, s80, s3
  buffer_load_dwordx4 v4, s[36:39], s80 offen offset:0  lds
  buffer_load_dwordx4 v5, s[36:39], s80 offen offset:1024  lds
  buffer_load_dwordx4 v6, s[36:39], s80 offen offset:2048  lds
  buffer_load_dwordx4 v7, s[36:39], s80 offen offset:3072  lds
  s_lshl_b32 s80, s29, 10
  s_lshl_b32 s81, s30, 7
  s_add_u32 s80, s80, s81
  s_lshl_b32 s81, s34, 5
  s_add_u32 s80, s80, s81
  s_lshl_b32 s80, s80, 10
  s_lshl_b32 s81, s31, 8
  s_add_u32 s80, s80, s81
  v_lshrrev_b32 v24, 1, v2
  v_lshlrev_b32 v24, 10, v24
  v_and_b32 v25, 1, v2
  v_lshl_add_u32 v24, v25, 7, v24
  buffer_load_dword v23, v24, s[56:59], s80 offen
  v_mov_b32 v28, 0
  buffer_load_dwordx2 v[30:31], v28, s[76:79], 0 offen sc1
  s_waitcnt vmcnt(22)
  s_barrier
  s_setprio 0
  s_add_u32 s80, s8, 98304
  v_xor_b32 v24, 0, v16
  v_add_u32 v24, s80, v24
  v_xor_b32 v25, 64, v16
  v_add_u32 v25, s80, v25
  v_xor_b32 v26, 128, v16
  v_add_u32 v26, s80, v26
  v_xor_b32 v27, 192, v16
  v_add_u32 v27, s80, v27
  ds_write_b128 v24, v[32:35] offset:0
  ds_write_b128 v25, v[36:39] offset:1024
  ds_write_b128 v26, v[40:43] offset:2048
  ds_write_b128 v27, v[44:47] offset:3072
  ds_write_b128 v24, v[48:51] offset:4096
  ds_write_b128 v25, v[52:55] offset:5120
  ds_write_b128 v26, v[56:59] offset:6144
  ds_write_b128 v27, v[60:63] offset:7168
  s_waitcnt vmcnt(2)
  s_barrier
  s_waitcnt lgkmcnt(0)
  s_add_u32 s80, s8, 131072
  v_xor_b32 v24, 0, v16
  v_add_u32 v24, s80, v24
  v_xor_b32 v25, 64, v16
  v_add_u32 v25, s80, v25
  v_xor_b32 v26, 128, v16
  v_add_u32 v26, s80, v26
  v_xor_b32 v27, 192, v16
  v_add_u32 v27, s80, v27
  ds_write_b128 v24, v[64:67] offset:0
  ds_write_b128 v25, v[68:71] offset:1024
  ds_write_b128 v26, v[72:75] offset:2048
  ds_write_b128 v27, v[76:79] offset:3072
  ds_write_b128 v24, v[80:83] offset:4096
  ds_write_b128 v25, v[84:87] offset:5120
  ds_write_b128 v26, v[88:91] offset:6144
  ds_write_b128 v27, v[92:95] offset:7168
  s_waitcnt lgkmcnt(0)
  v_add_u32 v24, s8, v17
  ds_write_b128 v24, v[96:99] offset:0
  ds_write_b128 v24, v[100:103] offset:1024
  ds_write_b128 v24, v[104:107] offset:2048
  ds_write_b128 v24, v[108:111] offset:3072
  ds_write_b128 v24, v[112:115] offset:4096
  ds_write_b128 v24, v[116:119] offset:5120
  ds_write_b128 v24, v[120:123] offset:6144
  ds_write_b128 v24, v[124:127] offset:7168
  s_waitcnt lgkmcnt(0)
P1_J:
  s_barrier
  s_lshl_b32 s35, s31, 2
  s_lshl_b32 s27, s29, 10
  s_lshl_b32 s80, s34, 4
  s_add_u32 s27, s27, s80
  s_lshl_b32 s27, s27, 10
  s_lshl_b32 s80, s31, 8
  s_add_u32 s27, s27, s80
  s_lshl_b32 s3, s26, 5
  s_lshl_b32 s80, s30, 2
  s_add_u32 s3, s3, s80
  s_add_u32 s3, s3, s34
  s_lshl_b32 s3, s3, 16
  s_waitcnt vmcnt(0)
  s_add_u32 s80, s8, 32768
  v_add_u32 v24, s80, v17
  ds_write_b128 v24, v[128:131] offset:0
  ds_write_b128 v24, v[132:135] offset:1024
  ds_write_b128 v24, v[136:139] offset:2048
  ds_write_b128 v24, v[140:143] offset:3072
  ds_write_b128 v24, v[144:147] offset:4096
  ds_write_b128 v24, v[148:151] offset:5120
  ds_write_b128 v24, v[152:155] offset:6144
  ds_write_b128 v24, v[156:159] offset:7168
  s_waitcnt lgkmcnt(0)
  s_barrier
  s_setprio 3
Lnonce_11:
  v_readfirstlane_b32 s84, v30
  v_readfirstlane_b32 s85, v31
  s_nop 3
  s_cmp_lg_u32 s84, 0
  s_cbranch_scc1 Lnonce_12
  buffer_load_dwordx2 v[30:31], v28, s[76:79], 0 offen sc1
  s_waitcnt vmcnt(0)
  s_branch Lnonce_11
Lnonce_12:
  s_add_u32 s80, s35, 0
  s_and_b32 s80, s80, 15
  s_lshl_b32 s80, s80, 16
  s_add_u32 m0, s9, 65536
  s_add_u32 s80, s80, s27
  buffer_load_dwordx4 v12, s[56:59], s80 offen offset:0  lds
  buffer_load_dwordx4 v13, s[56:59], s80 offen offset:1024  lds
  buffer_load_dwordx4 v14, s[56:59], s80 offen offset:2048  lds
  buffer_load_dwordx4 v15, s[56:59], s80 offen offset:3072  lds
  s_add_u32 s80, s35, 1
  s_and_b32 s80, s80, 15
  s_lshl_b32 s80, s80, 16
  s_add_u32 m0, s9, 81920
  s_add_u32 s80, s80, s27
  buffer_load_dwordx4 v12, s[56:59], s80 offen offset:0  lds
  buffer_load_dwordx4 v13, s[56:59], s80 offen offset:1024  lds
  buffer_load_dwordx4 v14, s[56:59], s80 offen offset:2048  lds
  buffer_load_dwordx4 v15, s[56:59], s80 offen offset:3072  lds
  s_lshl_b32 s10, s26, 3
  s_add_u32 s10, s10, s30
  s_lshl_b32 s10, s10, 2
  s_add_u32 s10, s10, s34
  s_lshl_b32 s10, s10, 6
  v_and_b32 v24, 7, v2
  v_lshrrev_b32 v25, 1, v24
  v_cmp_ne_u32 s[12:13], s31, v25
  s_add_u32 s80, s31, 1
  s_and_b32 s80, s80, 3
  v_cmp_eq_u32 s[16:17], s80, v25
  s_add_u32 s80, s31, 2
  s_and_b32 s80, s80, 3
  v_cmp_eq_u32 s[18:19], s80, v25
  s_add_u32 s80, s31, 3
  s_and_b32 s80, s80, 3
  v_cmp_eq_u32 s[20:21], s80, v25
  v_lshlrev_b32 v24, 3, v24
  v_mov_b32 v28, s84
  v_mov_b32 v29, s85
  s_mov_b32 s11, 0
  s_barrier
  s_add_u32 s80, s35, 2
  s_and_b32 s80, s80, 15
  s_lshl_b32 s80, s80, 16
  s_add_u32 m0, s9, 98304
  s_add_u32 s80, s80, s27
  buffer_load_dwordx4 v12, s[56:59], s80 offen offset:0  lds
  buffer_load_dwordx4 v13, s[56:59], s80 offen offset:1024  lds
  buffer_load_dwordx4 v14, s[56:59], s80 offen offset:2048  lds
  buffer_load_dwordx4 v15, s[56:59], s80 offen offset:3072  lds
  s_add_u32 s80, s35, 3
  s_and_b32 s80, s80, 15
  s_lshl_b32 s80, s80, 16
  s_add_u32 m0, s9, 114688
  s_add_u32 s80, s80, s27
  buffer_load_dwordx4 v12, s[56:59], s80 offen offset:0  lds
  buffer_load_dwordx4 v13, s[56:59], s80 offen offset:1024  lds
  buffer_load_dwordx4 v14, s[56:59], s80 offen offset:2048  lds
  buffer_load_dwordx4 v15, s[56:59], s80 offen offset:3072  lds
  s_waitcnt vmcnt(8)
  s_barrier
  s_waitcnt vmcnt(4)
  s_barrier
  s_waitcnt vmcnt(0)
Lp_13:
  s_add_u32 s80, s10, 16384
  buffer_load_dwordx2 v[26:27], v24, s[64:67], s80 offen sc1
  s_waitcnt vmcnt(0)
  v_cmp_ne_u64 vcc, v[26:27], v[28:29]
  s_nop 4
  s_and_b64 s[14:15], vcc, s[12:13]
  s_cselect_b32 s11, 0, 1
  s_and_b64 vcc, vcc, s[16:17]
  s_cbranch_vccz Lpd_14
  s_add_u32 s80, s10, 16384
  buffer_load_dwordx2 v[26:27], v24, s[64:67], s80 offen sc1
  s_waitcnt vmcnt(0)
  v_cmp_ne_u64 vcc, v[26:27], v[28:29]
  s_nop 4
  s_and_b64 s[14:15], vcc, s[12:13]
  s_cselect_b32 s11, 0, 1
  s_and_b64 vcc, vcc, s[16:17]
  s_cbranch_vccz Lpd_14
  s_add_u32 s80, s10, 16384
  buffer_load_dwordx2 v[26:27], v24, s[64:67], s80 offen sc1
  s_waitcnt vmcnt(0)
  v_cmp_ne_u64 vcc, v[26:27], v[28:29]
  s_nop 4
  s_and_b64 s[14:15], vcc, s[12:13]
  s_cselect_b32 s11, 0, 1
  s_and_b64 vcc, vcc, s[16:17]
  s_cbranch_vccz Lpd_14
  buffer_load_dwordx2 v[26:27], v24, s[64:67], s10 offen sc1
  s_waitcnt vmcnt(0)
  v_cmp_ne_u64 vcc, v[26:27], v[28:29]
  s_nop 4
  s_and_b64 s[14:15], vcc, s[12:13]
  s_cselect_b32 s11, 0, 1
  s_and_b64 vcc, vcc, s[16:17]
  s_cbranch_vccnz Lp_13
Lpd_14:
  s_add_u32 s80, s35, 4
  s_and_b32 s80, s80, 15
  s_lshl_b32 s80, s80, 12
  s_add_u32 m0, s9, 0
  s_add_u32 s80, s80, s3
  buffer_load_dwordx4 v3, s[52:55], s80 offen offset:0 sc1 lds
  buffer_load_dwordx4 v3, s[52:55], s80 offen offset:1024 sc1 lds
  buffer_load_dwordx4 v3, s[52:55], s80 offen offset:2048 sc1 lds
  buffer_load_dwordx4 v3, s[52:55], s80 offen offset:3072 sc1 lds
  s_add_u32 s80, s35, 4
  s_and_b32 s80, s80, 15
  s_lshl_b32 s80, s80, 16
  s_add_u32 m0, s9, 65536
  s_add_u32 s80, s80, s27
  buffer_load_dwordx4 v12, s[56:59], s80 offen offset:0  lds
  buffer_load_dwordx4 v13, s[56:59], s80 offen offset:1024  lds
  buffer_load_dwordx4 v14, s[56:59], s80 offen offset:2048  lds
  buffer_load_dwordx4 v15, s[56:59], s80 offen offset:3072  lds
  s_barrier
  s_add_u32 s80, s35, 5
  s_and_b32 s80, s80, 15
  s_lshl_b32 s80, s80, 12
  s_add_u32 m0, s9, 16384
  s_add_u32 s80, s80, s3
  buffer_load_dwordx4 v3, s[52:55], s80 offen offset:0 sc1 lds
  buffer_load_dwordx4 v3, s[52:55], s80 offen offset:1024 sc1 lds
  buffer_load_dwordx4 v3, s[52:55], s80 offen offset:2048 sc1 lds
  buffer_load_dwordx4 v3, s[52:55], s80 offen offset:3072 sc1 lds
  s_add_u32 s80, s35, 5
  s_and_b32 s80, s80, 15
  s_lshl_b32 s80, s80, 16
  s_add_u32 m0, s9, 81920
  s_add_u32 s80, s80, s27
  buffer_load_dwordx4 v12, s[56:59], s80 offen offset:0  lds
  buffer_load_dwordx4 v13, s[56:59], s80 offen offset:1024  lds
  buffer_load_dwordx4 v14, s[56:59], s80 offen offset:2048  lds
  buffer_load_dwordx4 v15, s[56:59], s80 offen offset:3072  lds
  s_waitcnt vmcnt(8)
  s_barrier
  s_add_u32 s80, s35, 6
  s_and_b32 s80, s80, 15
  s_lshl_b32 s80, s80, 12
  s_add_u32 m0, s9, 32768
  s_add_u32 s80, s80, s3
  buffer_load_dwordx4 v3, s[52:55], s80 offen offset:0 sc1 lds
  buffer_load_dwordx4 v3, s[52:55], s80 offen offset:1024 sc1 lds
  buffer_load_dwordx4 v3, s[52:55], s80 offen offset:2048 sc1 lds
  buffer_load_dwordx4 v3, s[52:55], s80 offen offset:3072 sc1 lds
  s_add_u32 s80, s35, 6
  s_and_b32 s80, s80, 15
  s_lshl_b32 s80, s80, 16
  s_add_u32 m0, s9, 98304
  s_add_u32 s80, s80, s27
  buffer_load_dwordx4 v12, s[56:59], s80 offen offset:0  lds
  buffer_load_dwordx4 v13, s[56:59], s80 offen offset:1024  lds
  buffer_load_dwordx4 v14, s[56:59], s80 offen offset:2048  lds
  buffer_load_dwordx4 v15, s[56:59], s80 offen offset:3072  lds
  s_waitcnt vmcnt(8)
  s_barrier
  s_add_u32 s80, s35, 7
  s_and_b32 s80, s80, 15
  s_lshl_b32 s80, s80, 12
  s_add_u32 m0, s9, 49152
  s_add_u32 s80, s80, s3
  buffer_load_dwordx4 v3, s[52:55], s80 offen offset:0 sc1 lds
  buffer_load_dwordx4 v3, s[52:55], s80 offen offset:1024 sc1 lds
  buffer_load_dwordx4 v3, s[52:55], s80 offen offset:2048 sc1 lds
  buffer_load_dwordx4 v3, s[52:55], s80 offen offset:3072 sc1 lds
  s_add_u32 s80, s35, 7
  s_and_b32 s80, s80, 15
  s_lshl_b32 s80, s80, 16
  s_add_u32 m0, s9, 114688
  s_add_u32 s80, s80, s27
  buffer_load_dwordx4 v12, s[56:59], s80 offen offset:0  lds
  buffer_load_dwordx4 v13, s[56:59], s80 offen offset:1024  lds
  buffer_load_dwordx4 v14, s[56:59], s80 offen offset:2048  lds
  buffer_load_dwordx4 v15, s[56:59], s80 offen offset:3072  lds
  s_waitcnt vmcnt(8)
  s_barrier
  s_cmp_lg_u32 s11, 0
  s_cbranch_scc1 Lpd_16
Lp_15:
  s_add_u32 s80, s10, 16384
  buffer_load_dwordx2 v[26:27], v24, s[64:67], s80 offen sc1
  s_waitcnt vmcnt(0)
  v_cmp_ne_u64 vcc, v[26:27], v[28:29]
  s_nop 4
  s_and_b64 s[14:15], vcc, s[12:13]
  s_cselect_b32 s11, 0, 1
  s_and_b64 vcc, vcc, s[18:19]
  s_cbranch_vccz Lpd_16
  s_add_u32 s80, s10, 16384
  buffer_load_dwordx2 v[26:27], v24, s[64:67], s80 offen sc1
  s_waitcnt vmcnt(0)
  v_cmp_ne_u64 vcc, v[26:27], v[28:29]
  s_nop 4
  s_and_b64 s[14:15], vcc, s[12:13]
  s_cselect_b32 s11, 0, 1
  s_and_b64 vcc, vcc, s[18:19]
  s_cbranch_vccz Lpd_16
  s_add_u32 s80, s10, 16384
  buffer_load_dwordx2 v[26:27], v24, s[64:67], s80 offen sc1
  s_waitcnt vmcnt(0)
  v_cmp_ne_u64 vcc, v[26:27], v[28:29]
  s_nop 4
  s_and_b64 s[14:15], vcc, s[12:13]
  s_cselect_b32 s11, 0, 1
  s_and_b64 vcc, vcc, s[18:19]
  s_cbranch_vccz Lpd_16
  buffer_load_dwordx2 v[26:27], v24, s[64:67], s10 offen sc1
  s_waitcnt vmcnt(0)
  v_cmp_ne_u64 vcc, v[26:27], v[28:29]
  s_nop 4
  s_and_b64 s[14:15], vcc, s[12:13]
  s_cselect_b32 s11, 0, 1
  s_and_b64 vcc, vcc, s[18:19]
  s_cbranch_vccnz Lp_15
Lpd_16:
  s_add_u32 s80, s35, 8
  s_and_b32 s80, s80, 15
  s_lshl_b32 s80, s80, 16
  s_add_u32 m0, s9, 65536
  s_add_u32 s80, s80, s27
  buffer_load_dwordx4 v12, s[56:59], s80 offen offset:0  lds
  buffer_load_dwordx4 v13, s[56:59], s80 offen offset:1024  lds
  buffer_load_dwordx4 v14, s[56:59], s80 offen offset:2048  lds
  buffer_load_dwordx4 v15, s[56:59], s80 offen offset:3072  lds
  s_add_u32 s80, s35, 8
  s_and_b32 s80, s80, 15
  s_lshl_b32 s80, s80, 12
  s_add_u32 m0, s9, 0
  s_add_u32 s80, s80, s3
  buffer_load_dwordx4 v3, s[52:55], s80 offen offset:0 sc1 lds
  buffer_load_dwordx4 v3, s[52:55], s80 offen offset:1024 sc1 lds
  buffer_load_dwordx4 v3, s[52:55], s80 offen offset:2048 sc1 lds
  buffer_load_dwordx4 v3, s[52:55], s80 offen offset:3072 sc1 lds
  s_waitcnt vmcnt(8)
  s_barrier
  s_add_u32 s80, s35, 9
  s_and_b32 s80, s80, 15
  s_lshl_b32 s80, s80, 16
  s_add_u32 m0, s9, 81920
  s_add_u32 s80, s80, s27
  buffer_load_dwordx4 v12, s[56:59], s80 offen offset:0  lds
  buffer_load_dwordx4 v13, s[56:59], s80 offen offset:1024  lds
  buffer_load_dwordx4 v14, s[56:59], s80 offen offset:2048  lds
  buffer_load_dwordx4 v15, s[56:59], s80 offen offset:3072  lds
  s_add_u32 s80, s35, 9
  s_and_b32 s80, s80, 15
  s_lshl_b32 s80, s80, 12
  s_add_u32 m0, s9, 16384
  s_add_u32 s80, s80, s3
  buffer_load_dwordx4 v3, s[52:55], s80 offen offset:0 sc1 lds
  buffer_load_dwordx4 v3, s[52:55], s80 offen offset:1024 sc1 lds
  buffer_load_dwordx4 v3, s[52:55], s80 offen offset:2048 sc1 lds
  buffer_load_dwordx4 v3, s[52:55], s80 offen offset:3072 sc1 lds
  s_waitcnt vmcnt(8)
  s_barrier
  s_add_u32 s80, s35, 10
  s_and_b32 s80, s80, 15
  s_lshl_b32 s80, s80, 16
  s_add_u32 m0, s9, 98304
  s_add_u32 s80, s80, s27
  buffer_load_dwordx4 v12, s[56:59], s80 offen offset:0  lds
  buffer_load_dwordx4 v13, s[56:59], s80 offen offset:1024  lds
  buffer_load_dwordx4 v14, s[56:59], s80 offen offset:2048  lds
  buffer_load_dwordx4 v15, s[56:59], s80 offen offset:3072  lds
  s_add_u32 s80, s35, 10
  s_and_b32 s80, s80, 15
  s_lshl_b32 s80, s80, 12
  s_add_u32 m0, s9, 32768
  s_add_u32 s80, s80, s3
  buffer_load_dwordx4 v3, s[52:55], s80 offen offset:0 sc1 lds
  buffer_load_dwordx4 v3, s[52:55], s80 offen offset:1024 sc1 lds
  buffer_load_dwordx4 v3, s[52:55], s80 offen offset:2048 sc1 lds
  buffer_load_dwordx4 v3, s[52:55], s80 offen offset:3072 sc1 lds
  s_waitcnt vmcnt(8)
  s_barrier
  s_add_u32 s80, s35, 11
  s_and_b32 s80, s80, 15
  s_lshl_b32 s80, s80, 16
  s_add_u32 m0, s9, 114688
  s_add_u32 s80, s80, s27
  buffer_load_dwordx4 v12, s[56:59], s80 offen offset:0  lds
  buffer_load_dwordx4 v13, s[56:59], s80 offen offset:1024  lds
  buffer_load_dwordx4 v14, s[56:59], s80 offen offset:2048  lds
  buffer_load_dwordx4 v15, s[56:59], s80 offen offset:3072  lds
  s_add_u32 s80, s35, 11
  s_and_b32 s80, s80, 15
  s_lshl_b32 s80, s80, 12
  s_add_u32 m0, s9, 49152
  s_add_u32 s80, s80, s3
  buffer_load_dwordx4 v3, s[52:55], s80 offen offset:0 sc1 lds
  buffer_load_dwordx4 v3, s[52:55], s80 offen offset:1024 sc1 lds
  buffer_load_dwordx4 v3, s[52:55], s80 offen offset:2048 sc1 lds
  buffer_load_dwordx4 v3, s[52:55], s80 offen offset:3072 sc1 lds
  s_waitcnt vmcnt(8)
  s_barrier
  s_cmp_lg_u32 s11, 0
  s_cbranch_scc1 Lpd_18
Lp_17:
  s_add_u32 s80, s10, 16384
  buffer_load_dwordx2 v[26:27], v24, s[64:67], s80 offen sc1
  s_waitcnt vmcnt(0)
  v_cmp_ne_u64 vcc, v[26:27], v[28:29]
  s_nop 4
  s_and_b64 s[14:15], vcc, s[12:13]
  s_cselect_b32 s11, 0, 1
  s_and_b64 vcc, vcc, s[20:21]
  s_cbranch_vccz Lpd_18
  s_add_u32 s80, s10, 16384
  buffer_load_dwordx2 v[26:27], v24, s[64:67], s80 offen sc1
  s_waitcnt vmcnt(0)
  v_cmp_ne_u64 vcc, v[26:27], v[28:29]
  s_nop 4
  s_and_b64 s[14:15], vcc, s[12:13]
  s_cselect_b32 s11, 0, 1
  s_and_b64 vcc, vcc, s[20:21]
  s_cbranch_vccz Lpd_18
  s_add_u32 s80, s10, 16384
  buffer_load_dwordx2 v[26:27], v24, s[64:67], s80 offen sc1
  s_waitcnt vmcnt(0)
  v_cmp_ne_u64 vcc, v[26:27], v[28:29]
  s_nop 4
  s_and_b64 s[14:15], vcc, s[12:13]
  s_cselect_b32 s11, 0, 1
  s_and_b64 vcc, vcc, s[20:21]
  s_cbranch_vccz Lpd_18
  buffer_load_dwordx2 v[26:27], v24, s[64:67], s10 offen sc1
  s_waitcnt vmcnt(0)
  v_cmp_ne_u64 vcc, v[26:27], v[28:29]
  s_nop 4
  s_and_b64 s[14:15], vcc, s[12:13]
  s_cselect_b32 s11, 0, 1
  s_and_b64 vcc, vcc, s[20:21]
  s_cbranch_vccnz Lp_17
Lpd_18:
  s_add_u32 s80, s35, 12
  s_and_b32 s80, s80, 15
  s_lshl_b32 s80, s80, 16
  s_add_u32 m0, s9, 65536
  s_add_u32 s80, s80, s27
  buffer_load_dwordx4 v12, s[56:59], s80 offen offset:0  lds
  buffer_load_dwordx4 v13, s[56:59], s80 offen offset:1024  lds
  buffer_load_dwordx4 v14, s[56:59], s80 offen offset:2048  lds
  buffer_load_dwordx4 v15, s[56:59], s80 offen offset:3072  lds
  s_add_u32 s80, s35, 12
  s_and_b32 s80, s80, 15
  s_lshl_b32 s80, s80, 12
  s_add_u32 m0, s9, 0
  s_add_u32 s80, s80, s3
  buffer_load_dwordx4 v3, s[52:55], s80 offen offset:0 sc1 lds
  buffer_load_dwordx4 v3, s[52:55], s80 offen offset:1024 sc1 lds
  buffer_load_dwordx4 v3, s[52:55], s80 offen offset:2048 sc1 lds
  buffer_load_dwordx4 v3, s[52:55], s80 offen offset:3072 sc1 lds
  s_waitcnt vmcnt(8)
  s_barrier
  s_add_u32 s80, s35, 13
  s_and_b32 s80, s80, 15
  s_lshl_b32 s80, s80, 16
  s_add_u32 m0, s9, 81920
  s_add_u32 s80, s80, s27
  buffer_load_dwordx4 v12, s[56:59], s80 offen offset:0  lds
  buffer_load_dwordx4 v13, s[56:59], s80 offen offset:1024  lds
  buffer_load_dwordx4 v14, s[56:59], s80 offen offset:2048  lds
  buffer_load_dwordx4 v15, s[56:59], s80 offen offset:3072  lds
  s_add_u32 s80, s35, 13
  s_and_b32 s80, s80, 15
  s_lshl_b32 s80, s80, 12
  s_add_u32 m0, s9, 16384
  s_add_u32 s80, s80, s3
  buffer_load_dwordx4 v3, s[52:55], s80 offen offset:0 sc1 lds
  buffer_load_dwordx4 v3, s[52:55], s80 offen offset:1024 sc1 lds
  buffer_load_dwordx4 v3, s[52:55], s80 offen offset:2048 sc1 lds
  buffer_load_dwordx4 v3, s[52:55], s80 offen offset:3072 sc1 lds
  s_waitcnt vmcnt(8)
  s_barrier
  s_add_u32 s80, s35, 14
  s_and_b32 s80, s80, 15
  s_lshl_b32 s80, s80, 16
  s_add_u32 m0, s9, 98304
  s_add_u32 s80, s80, s27
  buffer_load_dwordx4 v12, s[56:59], s80 offen offset:0  lds
  buffer_load_dwordx4 v13, s[56:59], s80 offen offset:1024  lds
  buffer_load_dwordx4 v14, s[56:59], s80 offen offset:2048  lds
  buffer_load_dwordx4 v15, s[56:59], s80 offen offset:3072  lds
  s_add_u32 s80, s35, 14
  s_and_b32 s80, s80, 15
  s_lshl_b32 s80, s80, 12
  s_add_u32 m0, s9, 32768
  s_add_u32 s80, s80, s3
  buffer_load_dwordx4 v3, s[52:55], s80 offen offset:0 sc1 lds
  buffer_load_dwordx4 v3, s[52:55], s80 offen offset:1024 sc1 lds
  buffer_load_dwordx4 v3, s[52:55], s80 offen offset:2048 sc1 lds
  buffer_load_dwordx4 v3, s[52:55], s80 offen offset:3072 sc1 lds
  s_waitcnt vmcnt(8)
  s_barrier
  s_add_u32 s80, s35, 15
  s_and_b32 s80, s80, 15
  s_lshl_b32 s80, s80, 16
  s_add_u32 m0, s9, 114688
  s_add_u32 s80, s80, s27
  buffer_load_dwordx4 v12, s[56:59], s80 offen offset:0  lds
  buffer_load_dwordx4 v13, s[56:59], s80 offen offset:1024  lds
  buffer_load_dwordx4 v14, s[56:59], s80 offen offset:2048  lds
  buffer_load_dwordx4 v15, s[56:59], s80 offen offset:3072  lds
  s_add_u32 s80, s35, 15
  s_and_b32 s80, s80, 15
  s_lshl_b32 s80, s80, 12
  s_add_u32 m0, s9, 49152
  s_add_u32 s80, s80, s3
  buffer_load_dwordx4 v3, s[52:55], s80 offen offset:0 sc1 lds
  buffer_load_dwordx4 v3, s[52:55], s80 offen offset:1024 sc1 lds
  buffer_load_dwordx4 v3, s[52:55], s80 offen offset:2048 sc1 lds
  buffer_load_dwordx4 v3, s[52:55], s80 offen offset:3072 sc1 lds
  s_waitcnt vmcnt(8)
  s_barrier
  s_waitcnt vmcnt(0)
  s_barrier
  s_barrier
  s_endpgm
K_END:
  s_endpgm
.section .rodata,"a"
.p2align 6
.amdhsa_kernel concat_heads__mha_block_cached__gqa_block_cached__near_ridge_kernel
  .amdhsa_next_free_vgpr 168
  .amdhsa_next_free_sgpr 102
  .amdhsa_accum_offset 168
  .amdhsa_group_segment_fixed_size 0
  .amdhsa_kernarg_size 104
  .amdhsa_user_sgpr_count 2
  .amdhsa_user_sgpr_kernarg_segment_ptr 1
  .amdhsa_system_sgpr_workgroup_id_x 1
.end_amdhsa_kernel
```
